```python
import torch

def _softmax(x, axis=-1):
    return torch.softmax(x, dim=axis)
def _gelu(x):
    return torch.nn.functional.gelu(x, approximate="tanh")
def _silu(x):
    return torch.nn.functional.silu(x)
def _sigmoid(x):
    return torch.sigmoid(x)
def _layernorm(x, axis=-1, eps=1e-5):
    m = x.mean(dim=axis, keepdim=True)
    v = x.var(dim=axis, keepdim=True, unbiased=False)
    return (x - m) / torch.sqrt(v + eps)
def _scatter_add(tgt, idx, src, axis=0):
    return tgt.clone().index_add_(axis, idx, src)
def _segment_sum(src, seg, n):
    out = torch.zeros((n,) + src.shape[1:], dtype=src.dtype)
    return out.index_add_(0, seg, src)
def _pad(x, pw):
    flat = tuple(v for pair in reversed(pw) for v in pair)
    return torch.nn.functional.pad(x, flat)

kernel_name = 'standalone__grouped_kv_mqa__prompt'

def setup_inputs():

    _w = (lambda a: (lambda t: t.to(torch.bfloat16) if t.is_floating_point() else t)(torch.as_tensor(a)))
    B, S, D, H = 1, 2048, 640, 32
    Dh = D // H
    return {
        "x": _w((lambda *s: torch.randn(*s, dtype=torch.bfloat16) * 0.05)(B, S, D)),
        "wq": _w((lambda *s: torch.randn(*s, dtype=torch.bfloat16) * 0.8)(D, H * Dh)),
        "wk": _w((lambda *s: torch.randn(*s, dtype=torch.bfloat16) * 0.8)(D, Dh)),
        "wv": _w((lambda *s: torch.randn(*s, dtype=torch.bfloat16) * 0.05)(D, Dh)),
        "wo": _w((lambda *s: torch.randn(*s, dtype=torch.bfloat16) * 0.05)(H * Dh, D)),
    }

def reference(x, wq, wk, wv, wo):
    B, S, D = x.shape
    H = 32
    Dh = D // H
    q = (lambda x, *d: x.permute(*d))((x @ wq).reshape(B, S, H, Dh), 0, 2, 1, 3)
    k = x @ wk
    v = x @ wv
    scores = torch.einsum("bhqd,bkd->bhqk", q, k) * (Dh ** -0.5)
    p = _softmax(scores, axis=-1)
    o = torch.einsum("bhqk,bkd->bhqd", p, v)
    return (lambda x, *d: x.permute(*d))(o, 0, 2, 1, 3).reshape(B, S, H * Dh) @ wo
```

```asm
; @launch grid=(256,1,1) block=(512,1,1) lds=163840
.amdgcn_target "amdgcn-amd-amdhsa--gfx950"
.text
.globl standalone__grouped_kv_mqa__prompt_kernel
.p2align 8
.type standalone__grouped_kv_mqa__prompt_kernel,@function
standalone__grouped_kv_mqa__prompt_kernel:

    s_cmp_ge_u32 s2, 256
    s_cbranch_scc1 L_end
    s_load_dwordx16 s[4:19], s[0:1], 0
    v_lshrrev_b32 v14, 6, v0
    v_and_b32 v1, 63, v0
    s_and_b32 s52, s2, 7
    s_lshr_b32 s54, s2, 3
    v_readfirstlane_b32 s44, v14
    s_and_b32 s47, s54, 7
    s_lshr_b32 s53, s54, 3
    s_lshl_b32 s48, s52, 2
    s_add_u32 s48, s48, s53
    v_lshrrev_b32 v14, 4, v0
    v_xor_b32 v14, v14, v0
    v_and_b32 v14, 7, v14
    v_bfe_u32 v225, v0, 3, 4
    v_mul_u32_u24 v225, 1280, v225
    v_lshl_add_u32 v225, v14, 4, v225
    s_and_b32 s81, s44, 3
    s_lshr_b32 s50, s47, 1
    s_lshr_b32 s55, s81, 1
    s_mul_i32 s55, s55, 640
    s_mul_i32 s77, s48, 81920
    s_add_u32 s77, s77, s55
    s_and_b32 s78, s81, 1
    s_lshl_b32 s78, s78, 6
    s_add_u32 s78, s78, s55
    s_lshl_b32 s78, s78, 4
    v_lshlrev_b32 v2, 4, v1
    s_mov_b32 s22, 2621440
    s_mov_b32 s23, 0x00020000
    s_mul_i32 s79, s81, 6400
    s_mul_i32 s62, s47, 160
    s_cmp_lt_u32 s44, 4
    s_cbranch_scc0 L_b1
    s_mul_i32 s80, s50, 20480
    s_add_u32 s54, s80, s77
    s_add_u32 s55, s80, s78
    s_waitcnt lgkmcnt(0)
    s_mov_b32 s20, s4
    s_mov_b32 s21, s5
    s_add_u32 m0, s55, 0
    s_nop 0
    buffer_load_dwordx4 v225, s[20:23], s54 offen offset:0 lds
    s_add_u32 m0, s55, 1920
    s_nop 0
    buffer_load_dwordx4 v225, s[20:23], s54 offen offset:128 lds
    s_add_u32 m0, s55, 3840
    s_nop 0
    buffer_load_dwordx4 v225, s[20:23], s54 offen offset:256 lds
    s_add_u32 m0, s55, 5760
    s_nop 0
    buffer_load_dwordx4 v225, s[20:23], s54 offen offset:384 lds
    s_add_u32 m0, s55, 7680
    s_nop 0
    buffer_load_dwordx4 v225, s[20:23], s54 offen offset:512 lds
    s_load_dword s51, s[18:19], 327680
    s_branch L_a2
L_b1:
    s_getpc_b64 s[74:75]
L_pc:
    s_lshr_b32 s54, s2, 3
    s_lshl_b32 s54, s54, 2
    s_add_u32 s54, s54, s81
    s_lshl_b32 s54, s54, 8
    v_lshlrev_b32 v14, 7, v1
    v_add_u32 v14, s54, v14
    v_min_u32 v14, L_last-L_pc, v14
    s_mov_b64 exec, 3
    global_load_dword v241, v14, s[74:75]
    s_mov_b64 exec, -1
    s_mov_b32 s30, 25600
    s_mov_b32 s31, 0x00020000
    s_mov_b32 s26, 819200
    s_mov_b32 s27, 0x00020000
    s_lshl_b32 s66, s81, 10
    s_mul_i32 s67, s53, 163840
    s_add_u32 s67, s67, s62
    v_lshlrev_b32 v242, 7, v1
    s_lshr_b32 s3, s2, 4
    s_lshl_b32 s3, s3, 2
    s_add_u32 s3, s3, s81
    s_lshl_b32 s3, s3, 9
    v_and_b32 v43, 255, v0
    s_movk_i32 s54, 1120
    s_movk_i32 s55, 1280
    s_movk_i32 s56, -960
    v_mul_u32_u24 v15, 6554, v43
    v_lshlrev_b32 v38, 4, v43
    v_lshrrev_b32 v15, 16, v15
    v_mad_u32_u24 v38, v15, s54, v38
    v_and_b32 v14, 12, v15
    v_mad_u32_u24 v38, v14, s55, v38
    v_and_b32 v14, 16, v15
    v_mad_i32_i24 v38, v14, s56, v38
    v_add_u32 v43, 256, v43
    v_mul_u32_u24 v15, 6554, v43
    v_lshlrev_b32 v39, 4, v43
    v_lshrrev_b32 v15, 16, v15
    v_mad_u32_u24 v39, v15, s54, v39
    v_and_b32 v14, 12, v15
    v_mad_u32_u24 v39, v14, s55, v39
    v_and_b32 v14, 16, v15
    v_mad_i32_i24 v39, v14, s56, v39
    v_add_u32 v43, 256, v43
    v_mul_u32_u24 v15, 6554, v43
    v_lshlrev_b32 v40, 4, v43
    v_lshrrev_b32 v15, 16, v15
    v_mad_u32_u24 v40, v15, s54, v40
    v_and_b32 v14, 12, v15
    v_mad_u32_u24 v40, v14, s55, v40
    v_and_b32 v14, 16, v15
    v_mad_i32_i24 v40, v14, s56, v40
    v_add_u32 v43, 256, v43
    v_mul_u32_u24 v15, 6554, v43
    v_lshlrev_b32 v41, 4, v43
    v_lshrrev_b32 v15, 16, v15
    v_mad_u32_u24 v41, v15, s54, v41
    v_and_b32 v14, 12, v15
    v_mad_u32_u24 v41, v14, s55, v41
    v_and_b32 v14, 16, v15
    v_mad_i32_i24 v41, v14, s56, v41
    v_add_u32 v43, 256, v43
    v_mul_u32_u24 v15, 6554, v43
    v_lshlrev_b32 v42, 4, v43
    v_lshrrev_b32 v15, 16, v15
    v_mad_u32_u24 v42, v15, s54, v42
    v_and_b32 v14, 12, v15
    v_mad_u32_u24 v42, v14, s55, v42
    v_and_b32 v14, 16, v15
    v_mad_i32_i24 v42, v14, s56, v42
    s_waitcnt lgkmcnt(0)
    s_bitcmp1_b32 s47, 0
    s_cselect_b32 s28, s10, s8
    s_cselect_b32 s29, s11, s9
    s_mov_b64 exec, 15
    buffer_load_dword v241, v242, s[28:31], s3 offen
    s_mov_b64 exec, -1
    s_load_dword s51, s[18:19], 327680
    s_mov_b32 s20, s4
    s_mov_b32 s21, s5
    s_mov_b32 s24, s6
    s_mov_b32 s25, s7
    s_add_u32 m0, s79, 122880
    s_nop 0
    buffer_load_dwordx4 v2, s[28:31], s79 offen offset:0 lds
    buffer_load_dwordx4 v2, s[28:31], s79 offen offset:1024 lds
    buffer_load_dwordx4 v2, s[28:31], s79 offen offset:2048 lds
    buffer_load_dwordx4 v2, s[28:31], s79 offen offset:3072 lds
    s_add_u32 m0, s79, 126976
    s_add_u32 s54, s79, 4096
    buffer_load_dwordx4 v2, s[28:31], s54 offen offset:0 lds
    buffer_load_dwordx4 v2, s[28:31], s54 offen offset:1024 lds
    s_mov_b64 exec, 0xffff
    buffer_load_dwordx4 v2, s[28:31], s54 offen offset:2048 lds
    s_mov_b64 exec, -1
    s_setprio 2
    s_add_u32 s57, s50, 1
    s_and_b32 s57, s57, 3
    s_mul_i32 s55, s57, 20480
    s_add_u32 s54, s55, s77
    s_add_u32 s55, s55, s78
    s_add_u32 m0, s55, 0
    s_nop 0
    buffer_load_dwordx4 v225, s[20:23], s54 offen offset:0 lds
    s_add_u32 m0, s55, 1920
    s_nop 0
    buffer_load_dwordx4 v225, s[20:23], s54 offen offset:128 lds
    s_add_u32 m0, s55, 3840
    s_nop 0
    buffer_load_dwordx4 v225, s[20:23], s54 offen offset:256 lds
    s_add_u32 m0, s55, 5760
    s_nop 0
    buffer_load_dwordx4 v225, s[20:23], s54 offen offset:384 lds
    s_add_u32 m0, s55, 7680
    s_nop 0
    buffer_load_dwordx4 v225, s[20:23], s54 offen offset:512 lds
    s_add_u32 s57, s50, 2
    s_and_b32 s57, s57, 3
    s_mul_i32 s55, s57, 20480
    s_add_u32 s54, s55, s77
    s_add_u32 s55, s55, s78
    s_add_u32 m0, s55, 0
    s_nop 0
    buffer_load_dwordx4 v225, s[20:23], s54 offen offset:0 lds
    s_add_u32 m0, s55, 1920
    s_nop 0
    buffer_load_dwordx4 v225, s[20:23], s54 offen offset:128 lds
    s_add_u32 m0, s55, 3840
    s_nop 0
    buffer_load_dwordx4 v225, s[20:23], s54 offen offset:256 lds
    s_add_u32 m0, s55, 5760
    s_nop 0
    buffer_load_dwordx4 v225, s[20:23], s54 offen offset:384 lds
    s_add_u32 m0, s55, 7680
    s_nop 0
    buffer_load_dwordx4 v225, s[20:23], s54 offen offset:512 lds
    s_waitcnt vmcnt(10)
    s_barrier
    s_add_u32 s57, s50, 3
    s_and_b32 s57, s57, 3
    s_mul_i32 s55, s57, 20480
    s_add_u32 s54, s55, s77
    s_add_u32 s55, s55, s78
    s_add_u32 m0, s55, 0
    s_nop 0
    buffer_load_dwordx4 v225, s[20:23], s54 offen offset:0 lds
    s_add_u32 m0, s55, 1920
    s_nop 0
    buffer_load_dwordx4 v225, s[20:23], s54 offen offset:128 lds
    s_add_u32 m0, s55, 3840
    s_nop 0
    buffer_load_dwordx4 v225, s[20:23], s54 offen offset:256 lds
    s_add_u32 m0, s55, 5760
    s_nop 0
    buffer_load_dwordx4 v225, s[20:23], s54 offen offset:384 lds
    s_add_u32 m0, s55, 7680
    s_nop 0
    buffer_load_dwordx4 v225, s[20:23], s54 offen offset:512 lds
    s_add_u32 m0, s66, 81920
    s_nop 0
    buffer_load_dwordx4 v38, s[24:27], s67 offen lds
    s_add_u32 m0, s66, 86016
    s_nop 0
    buffer_load_dwordx4 v39, s[24:27], s67 offen lds
    s_add_u32 m0, s66, 90112
    s_nop 0
    buffer_load_dwordx4 v40, s[24:27], s67 offen lds
    s_add_u32 m0, s66, 94208
    s_nop 0
    buffer_load_dwordx4 v41, s[24:27], s67 offen lds
    s_add_u32 m0, s66, 98304
    s_nop 0
    buffer_load_dwordx4 v42, s[24:27], s67 offen lds
    s_waitcnt lgkmcnt(0)
    s_mul_i32 s51, s51, 1664525
    s_add_u32 s51, s51, 1013904223
    s_waitcnt vmcnt(5)
    s_barrier
    s_add_u32 s67, s67, 163840
    s_sub_u32 s68, s67, 819200
    s_min_u32 s67, s67, s68
    s_add_u32 m0, s66, 102400
    s_nop 0
    buffer_load_dwordx4 v38, s[24:27], s67 offen lds
    s_add_u32 m0, s66, 106496
    s_nop 0
    buffer_load_dwordx4 v39, s[24:27], s67 offen lds
    s_add_u32 m0, s66, 110592
    s_nop 0
    buffer_load_dwordx4 v40, s[24:27], s67 offen lds
    s_mov_b32 s40, s18
    s_mov_b32 s41, s19
    s_mov_b32 s42, 8388608
    s_mov_b32 s43, 0x00020000
    s_mov_b32 s32, s12
    s_mov_b32 s33, s13
    s_mov_b32 s34, 819200
    s_mov_b32 s35, 0x00020000
    s_mov_b32 s36, s14
    s_mov_b32 s37, s15
    s_mov_b32 s38, 2621440
    s_mov_b32 s39, 0x00020000
    s_lshr_b32 s82, s44, 2
    s_lshr_b32 s45, s44, 1
    s_nop 0
    s_and_b32 s83, s45, 1
    s_xor_b32 s69, s83, s82
    s_and_b32 s46, s44, 1
    s_mov_b32 s85, 0
    s_lshl_b32 s49, s48, 2
    s_add_u32 s49, s49, s45
    s_mul_i32 s63, s44, 640
    s_getreg_b32 s59, hwreg(HW_REG_XCC_ID, 0, 3)
    s_mov_b32 s64, 0
    s_mul_i32 s65, s49, 20480
    s_add_u32 s65, s65, 1048576
    s_lshl_b32 s56, s62, 4
    s_add_u32 s56, s56, s65
    s_lshl_b32 s57, s46, 10
    s_add_u32 s60, s56, s57
    s_lshl_b32 s57, s46, 2
    s_add_u32 s61, s56, s57
    s_add_u32 s61, s61, 2048
    s_lshl_b32 s76, s49, 4
    s_lshl_b32 s54, s47, 1
    s_add_u32 s54, s54, s46
    s_add_u32 s76, s76, s54
    s_lshl_b32 s76, s76, 7
    s_add_u32 s76, s76, 524288
    s_mul_i32 s55, s81, 25600
    v_mul_u32_u24 v243, 40, v1
    v_and_b32 v14, 3, v1
    v_lshlrev_b32 v14, 5, v14
    v_sub_u32 v8, v243, v14
    v_add_u32 v8, s55, v8
    s_waitcnt vmcnt(5)
    s_barrier
    s_add_u32 m0, s66, 114688
    s_nop 0
    buffer_load_dwordx4 v41, s[24:27], s67 offen lds
    s_add_u32 m0, s66, 118784
    s_nop 0
    buffer_load_dwordx4 v42, s[24:27], s67 offen lds
    s_load_dword s84, s[18:19], s60
    s_mul_i32 s54, s49, 20480
    s_add_u32 s54, s54, s62
    s_load_dword s84, s[14:15], s54
    s_load_dword s84, s[12:13], s62
    v_mul_u32_u24 v14, 6554, v1
    v_lshrrev_b32 v14, 16, v14
    v_mul_u32_u24 v15, 10, v14
    v_sub_u32 v15, v1, v15
    v_lshlrev_b32 v15, 4, v15
    v_mul_u32_u24 v6, 1280, v14
    v_add_u32 v6, v6, v15
    v_lshrrev_b32 v7, 1, v14
    v_mul_u32_u24 v7, 38, v7
    v_add_u32 v7, v7, v14
    v_mul_u32_u24 v7, 1280, v7
    v_add_u32 v7, v7, v15
    s_and_b32 s54, s81, 1
    s_mul_i32 s54, s54, 20
    s_and_b32 s55, s81, 2
    s_lshl_b32 s56, s55, 1
    s_add_u32 s56, s56, s54
    s_lshl_b32 s57, s82, 3
    s_add_u32 s56, s56, s57
    s_mul_i32 s56, s56, 1280
    v_add_u32 v6, s56, v6
    s_add_u32 s54, s54, s55
    s_xor_b32 s57, s82, s47
    s_andn2_b32 s57, 1, s57
    s_mul_i32 s57, s57, 80
    s_add_u32 s54, s54, s57
    s_add_u32 s54, s54, 16
    s_mul_i32 s54, s54, 1280
    v_add_u32 v7, s54, v7
    s_waitcnt vmcnt(5)
    s_barrier
    s_add_u32 s67, s67, 163840
    s_sub_u32 s68, s67, 819200
    s_min_u32 s67, s67, s68
    s_add_u32 m0, s66, 122880
    s_nop 0
    buffer_load_dwordx4 v38, s[24:27], s67 offen lds
    s_add_u32 m0, s66, 126976
    s_nop 0
    buffer_load_dwordx4 v39, s[24:27], s67 offen lds
    s_add_u32 m0, s66, 131072
    s_nop 0
    buffer_load_dwordx4 v40, s[24:27], s67 offen lds
    s_xor_b32 s54, s47, 3
    s_and_b32 s54, s54, 3
    s_mul_i32 s54, s54, 102400
    s_add_u32 s86, s54, s62
    s_xor_b32 s54, s47, 2
    s_and_b32 s54, s54, 3
    s_mul_i32 s54, s54, 102400
    s_add_u32 s87, s54, s62
    s_xor_b32 s54, s47, 1
    s_and_b32 s54, s54, 3
    s_mul_i32 s54, s54, 102400
    s_add_u32 s88, s54, s62
    s_xor_b32 s54, s47, 0
    s_and_b32 s54, s54, 3
    s_mul_i32 s54, s54, 102400
    s_add_u32 s89, s54, s62
    s_lshl_b32 s55, s82, 1
    s_add_u32 s55, s55, s46
    s_mul_i32 s54, s55, 12288
    s_add_u32 s54, s54, 102400
    v_add_u32 v9, s54, v2
    s_xor_b32 s54, s55, 1
    s_mul_i32 s54, s54, 12288
    s_add_u32 s54, s54, 102400
    v_add_u32 v10, s54, v2
    s_mul_i32 s54, s69, 6144
    v_add_u32 v11, s54, v10
    s_mul_i32 s54, s69, 9216
    v_add_u32 v12, s54, v9
    v_and_b32 v14, 31, v1
    v_lshlrev_b32 v3, 4, v14
    v_lshrrev_b32 v15, 5, v1
    v_mul_u32_u24 v15, 384, v15
    v_add_u32 v4, v3, v15
    v_mov_b32 v15, 1073741824
    s_mov_b32 vcc_lo, 0xff880000
    s_mov_b32 vcc_hi, 0xff880000
    v_cndmask_b32 v4, v4, v15, vcc
    v_lshlrev_b32 v16, 3, v1
    s_lshl_b32 s54, s83, 1
    s_add_u32 s54, s54, s46
    s_lshl_b32 s58, s52, 15
    s_lshl_b32 s55, s54, 13
    s_add_u32 s58, s58, s55
    v_lshrrev_b32 v5, 3, v1
    v_add_u32 v5, s52, v5
    v_and_b32 v5, 7, v5
    v_lshlrev_b32 v5, 5, v5
    v_and_b32 v15, 7, v1
    v_add_u32 v5, v5, v15
    v_lshlrev_b32 v5, 7, v5
    s_lshl_b32 s55, s54, 10
    s_add_u32 s55, s55, 262144
    v_add_u32 v5, s55, v5
    s_lshl_b32 s55, s54, 6
    s_add_u32 s55, s55, 153632
    v_lshl_add_u32 v248, v1, 2, s55
    s_waitcnt vmcnt(5)
    s_barrier
    s_add_u32 m0, s66, 135168
    s_nop 0
    buffer_load_dwordx4 v41, s[24:27], s67 offen lds
    s_add_u32 m0, s66, 139264
    s_nop 0
    buffer_load_dwordx4 v42, s[24:27], s67 offen lds
    s_and_b32 s54, s45, 2
    s_mul_i32 s54, s54, 2560
    s_add_u32 s54, s54, 143360
    s_add_u32 s55, s54, 2560
    v_lshrrev_b32 v14, 5, v1
    v_lshl_add_u32 v14, v14, 10, v3
    s_lshl_b32 s56, s46, 9
    s_xor_b32 s57, s56, 512
    v_add_u32 v15, s57, v14
    v_add_u32 v231, s54, v15
    v_add_u32 v233, s55, v15
    v_add_u32 v15, s56, v14
    v_add_u32 v232, s54, v15
    v_add_u32 v234, s55, v15
    s_lshr_b32 s57, s57, 1
    v_xor_b32 v15, s57, v16
    v_add_u32 v235, s54, v15
    v_add_u32 v236, s55, v15
    v_lshrrev_b32 v3, 1, v3
    v_and_b32 v15, 32, v1
    v_lshl_add_u32 v3, v15, 7, v3
    v_and_b32 v240, 0xfffff3ff, v5
    v_or_b32 v240, s66, v240
    s_lshl_b32 s54, s81, 6
    s_add_u32 s54, s54, 153632
    v_lshl_add_u32 v237, v1, 2, s54
    v_lshlrev_b32 v14, 2, v1
    v_add_u32 v14, 153888, v14
    v_mov_b32 v15, 0
    s_mov_b64 exec, 0xffff
    ds_write_b32 v14, v15
    s_mov_b64 exec, -1
    s_waitcnt vmcnt(5)
    s_barrier
    s_add_u32 s67, s67, 163840
    s_sub_u32 s68, s67, 819200
    s_min_u32 s67, s67, s68
    s_add_u32 m0, s66, 0
    s_nop 0
    buffer_load_dwordx4 v38, s[24:27], s67 offen lds
    s_add_u32 m0, s66, 4096
    s_nop 0
    buffer_load_dwordx4 v39, s[24:27], s67 offen lds
    s_add_u32 m0, s66, 8192
    s_nop 0
    buffer_load_dwordx4 v40, s[24:27], s67 offen lds
    v_mul_u32_u24 v14, 52, v1
    v_lshrrev_b32 v14, 9, v14
    s_mul_i32 s54, s81, 704
    v_lshl_add_u32 v250, v14, 4, v2
    v_add_u32 v250, s54, v250
    v_add_u32 v251, 51200, v250
    v_mul_u32_u24 v253, 1120, v14
    v_add_u32 v253, v253, v2
    s_mul_i32 s65, s48, 81920
    s_mul_i32 s54, s81, 5120
    s_add_u32 s65, s65, s54
    s_add_u32 s65, s65, s62
    v_mov_b32 v102, 0
    v_mov_b32 v103, 0
    v_mov_b32 v104, 0xdddddddd
    s_nop 0
    v_mfma_f32_32x32x4_2b_bf16 v[118:149], v[102:103], v[102:103], 0
    v_mfma_f32_32x32x4_2b_bf16 v[150:181], v[102:103], v[102:103], 0
    s_waitcnt vmcnt(5)
    s_barrier
    s_add_u32 m0, s66, 12288
    s_nop 0
    buffer_load_dwordx4 v41, s[24:27], s67 offen lds
    s_add_u32 m0, s66, 16384
    s_nop 0
    buffer_load_dwordx4 v42, s[24:27], s67 offen lds
    s_waitcnt vmcnt(5)
    s_barrier
    s_add_u32 s67, s67, 163840
    s_sub_u32 s68, s67, 819200
    s_min_u32 s67, s67, s68
    s_add_u32 m0, s66, 20480
    s_nop 0
    buffer_load_dwordx4 v38, s[24:27], s67 offen lds
    s_add_u32 m0, s66, 24576
    s_nop 0
    buffer_load_dwordx4 v39, s[24:27], s67 offen lds
    s_add_u32 m0, s66, 28672
    s_nop 0
    buffer_load_dwordx4 v40, s[24:27], s67 offen lds
    s_waitcnt vmcnt(5)
    s_barrier
    s_add_u32 m0, s66, 32768
    s_nop 0
    buffer_load_dwordx4 v41, s[24:27], s67 offen lds
    s_add_u32 m0, s66, 36864
    s_nop 0
    buffer_load_dwordx4 v42, s[24:27], s67 offen lds
    s_mov_b64 exec, 0xffff
    buffer_load_dword v15, v240, s[40:43], 0 offen sc1
    s_mov_b64 exec, -1
    s_waitcnt vmcnt(6)
    s_barrier
    s_waitcnt vmcnt(3)
    s_barrier
    s_waitcnt vmcnt(1)
    s_barrier
    s_waitcnt vmcnt(0)
L_f0:
    s_mov_b64 exec, 0xff
    v_cmp_ne_u32 vcc, s51, v15
    s_cbranch_vccnz L_slowf0
    s_mov_b64 exec, 0xffff
    ds_write_b32 v237, v15
    s_mov_b64 exec, -1
    buffer_load_dwordx4 v[182:185], v2, s[40:43], s58 offen
    buffer_load_dwordx2 v[186:187], v3, s[40:43], s58 offen offset:1024
    buffer_load_dwordx4 v[200:203], v4, s[40:43], s58 offen offset:1536
    buffer_load_dwordx4 v[204:207], v4, s[40:43], s58 offen offset:2304
    s_add_u32 s58, s58, 4096
    buffer_load_dwordx4 v[188:191], v2, s[40:43], s58 offen
    s_waitcnt lgkmcnt(0)
    s_barrier
    s_branch L_bq
    s_endpgm
    s_endpgm
    s_endpgm
    s_endpgm
    s_endpgm
    s_endpgm
    s_endpgm
    s_endpgm
    s_endpgm
    s_endpgm
    s_endpgm
    s_endpgm
    s_endpgm
    s_endpgm
    s_endpgm
    s_endpgm
    s_endpgm
    s_endpgm
    s_endpgm
    s_endpgm
    s_endpgm
    s_endpgm
    s_endpgm
    s_endpgm
    s_endpgm
    s_endpgm
    s_endpgm
    s_endpgm
    s_endpgm
    s_endpgm
    s_endpgm
    s_endpgm
    s_endpgm
    s_endpgm
    s_endpgm
    s_endpgm
    s_endpgm
L_a2:
    s_mov_b32 s40, s18
    s_mov_b32 s41, s19
    s_mov_b32 s42, 8388608
    s_mov_b32 s43, 0x00020000
    s_mov_b32 s32, s12
    s_mov_b32 s33, s13
    s_mov_b32 s34, 819200
    s_mov_b32 s35, 0x00020000
    s_mov_b32 s36, s14
    s_mov_b32 s37, s15
    s_mov_b32 s38, 2621440
    s_mov_b32 s39, 0x00020000
    s_lshr_b32 s82, s44, 2
    s_lshr_b32 s45, s44, 1
    s_nop 0
    s_and_b32 s83, s45, 1
    s_xor_b32 s69, s83, s82
    s_and_b32 s46, s44, 1
    s_mov_b32 s85, 0
    s_lshl_b32 s49, s48, 2
    s_add_u32 s49, s49, s45
    s_mul_i32 s63, s44, 640
    s_getreg_b32 s59, hwreg(HW_REG_XCC_ID, 0, 3)
    s_mov_b32 s64, 0
    s_mul_i32 s65, s49, 20480
    s_add_u32 s65, s65, 1048576
    s_lshl_b32 s56, s62, 4
    s_add_u32 s56, s56, s65
    s_lshl_b32 s57, s46, 10
    s_add_u32 s60, s56, s57
    s_lshl_b32 s57, s46, 2
    s_add_u32 s61, s56, s57
    s_add_u32 s61, s61, 2048
    s_lshl_b32 s76, s49, 4
    s_lshl_b32 s54, s47, 1
    s_add_u32 s54, s54, s46
    s_add_u32 s76, s76, s54
    s_lshl_b32 s76, s76, 7
    s_add_u32 s76, s76, 524288
    s_mul_i32 s55, s81, 25600
    v_mul_u32_u24 v243, 40, v1
    v_and_b32 v14, 3, v1
    v_lshlrev_b32 v14, 5, v14
    v_sub_u32 v8, v243, v14
    v_add_u32 v8, s55, v8
    v_mul_u32_u24 v14, 6554, v1
    v_lshrrev_b32 v14, 16, v14
    v_mul_u32_u24 v15, 10, v14
    v_sub_u32 v15, v1, v15
    v_lshlrev_b32 v15, 4, v15
    v_mul_u32_u24 v6, 1280, v14
    v_add_u32 v6, v6, v15
    v_lshrrev_b32 v7, 1, v14
    v_mul_u32_u24 v7, 38, v7
    v_add_u32 v7, v7, v14
    v_mul_u32_u24 v7, 1280, v7
    v_add_u32 v7, v7, v15
    s_and_b32 s54, s81, 1
    s_mul_i32 s54, s54, 20
    s_and_b32 s55, s81, 2
    s_lshl_b32 s56, s55, 1
    s_add_u32 s56, s56, s54
    s_lshl_b32 s57, s82, 3
    s_add_u32 s56, s56, s57
    s_mul_i32 s56, s56, 1280
    v_add_u32 v6, s56, v6
    s_add_u32 s54, s54, s55
    s_xor_b32 s57, s82, s47
    s_andn2_b32 s57, 1, s57
    s_mul_i32 s57, s57, 80
    s_add_u32 s54, s54, s57
    s_add_u32 s54, s54, 16
    s_mul_i32 s54, s54, 1280
    v_add_u32 v7, s54, v7
    s_xor_b32 s54, s47, 3
    s_and_b32 s54, s54, 3
    s_mul_i32 s54, s54, 102400
    s_add_u32 s86, s54, s62
    s_xor_b32 s54, s47, 2
    s_and_b32 s54, s54, 3
    s_mul_i32 s54, s54, 102400
    s_add_u32 s87, s54, s62
    s_xor_b32 s54, s47, 1
    s_and_b32 s54, s54, 3
    s_mul_i32 s54, s54, 102400
    s_add_u32 s88, s54, s62
    s_xor_b32 s54, s47, 0
    s_and_b32 s54, s54, 3
    s_mul_i32 s54, s54, 102400
    s_add_u32 s89, s54, s62
    s_lshl_b32 s55, s82, 1
    s_add_u32 s55, s55, s46
    s_mul_i32 s54, s55, 12288
    s_add_u32 s54, s54, 102400
    v_add_u32 v9, s54, v2
    s_xor_b32 s54, s55, 1
    s_mul_i32 s54, s54, 12288
    s_add_u32 s54, s54, 102400
    v_add_u32 v10, s54, v2
    s_mul_i32 s54, s69, 6144
    v_add_u32 v11, s54, v10
    s_mul_i32 s54, s69, 9216
    v_add_u32 v12, s54, v9
    v_and_b32 v14, 31, v1
    v_lshlrev_b32 v3, 4, v14
    v_lshrrev_b32 v15, 5, v1
    v_mul_u32_u24 v15, 384, v15
    v_add_u32 v4, v3, v15
    v_mov_b32 v15, 1073741824
    s_mov_b32 vcc_lo, 0xff880000
    s_mov_b32 vcc_hi, 0xff880000
    v_cndmask_b32 v4, v4, v15, vcc
    v_lshlrev_b32 v16, 3, v1
    s_lshl_b32 s54, s83, 1
    s_add_u32 s54, s54, s46
    s_lshl_b32 s58, s52, 15
    s_lshl_b32 s55, s54, 13
    s_add_u32 s58, s58, s55
    v_lshrrev_b32 v5, 3, v1
    v_add_u32 v5, s52, v5
    v_and_b32 v5, 7, v5
    v_lshlrev_b32 v5, 5, v5
    v_and_b32 v15, 7, v1
    v_add_u32 v5, v5, v15
    v_lshlrev_b32 v5, 7, v5
    s_lshl_b32 s55, s54, 10
    s_add_u32 s55, s55, 262144
    v_add_u32 v5, s55, v5
    s_lshl_b32 s55, s54, 6
    s_add_u32 s55, s55, 153632
    v_lshl_add_u32 v248, v1, 2, s55
    s_and_b32 s54, s45, 2
    s_mul_i32 s54, s54, 2560
    s_add_u32 s54, s54, 143360
    s_add_u32 s55, s54, 2560
    v_lshrrev_b32 v14, 5, v1
    v_lshl_add_u32 v14, v14, 10, v3
    s_lshl_b32 s56, s46, 9
    s_xor_b32 s57, s56, 512
    v_add_u32 v15, s57, v14
    v_add_u32 v231, s54, v15
    v_add_u32 v233, s55, v15
    v_add_u32 v15, s56, v14
    v_add_u32 v232, s54, v15
    v_add_u32 v234, s55, v15
    s_lshr_b32 s57, s57, 1
    v_xor_b32 v15, s57, v16
    v_add_u32 v235, s54, v15
    v_add_u32 v236, s55, v15
    v_lshrrev_b32 v3, 1, v3
    v_and_b32 v15, 32, v1
    v_lshl_add_u32 v3, v15, 7, v3
    v_and_b32 v254, 15, v1
    v_mul_u32_u24 v254, 176, v254
    v_bfe_u32 v15, v1, 4, 1
    s_mul_i32 s54, s81, 25600
    v_mul_u32_u24 v15, 2816, v15
    v_add3_u32 v254, v254, v15, s54
    v_lshrrev_b32 v15, 5, v1
    v_lshl_add_u32 v254, v15, 4, v254
    v_mov_b32 v253, 0
    s_add_u32 s79, s79, 122880
    v_bfe_u32 v14, v1, 1, 3
    v_lshrrev_b32 v15, 4, v1
    v_xor_b32 v14, v14, v15
    v_and_b32 v15, 15, v1
    v_lshlrev_b32 v15, 7, v15
    v_lshl_add_u32 v14, v14, 4, v15
    s_lshl_b32 s56, s46, 6
    v_xor_b32 v237, s56, v14
    s_mul_i32 s56, s46, 3072
    s_add_u32 s56, s56, s78
    s_add_u32 s56, s56, s80
    v_add_u32 v237, s56, v237
    s_lshl_b32 s56, s46, 11
    v_xor_b32 v247, 64, v237
    v_add_u32 v247, s56, v247
    v_add_u32 v244, 81920, v243
    s_mul_i32 s54, s81, 20480
    v_add_u32 v14, s54, v14
    s_lshl_b32 s54, s53, 12
    v_add_u32 v226, s54, v14
    s_add_u32 s54, s54, 4096
    s_sub_u32 s55, s54, 20480
    s_min_u32 s54, s54, s55
    v_add_u32 v227, s54, v14
    s_add_u32 s54, s54, 4096
    s_sub_u32 s55, s54, 20480
    s_min_u32 s54, s54, s55
    v_add_u32 v228, s54, v14
    s_add_u32 s54, s54, 4096
    s_sub_u32 s55, s54, 20480
    s_min_u32 s54, s54, s55
    v_add_u32 v229, s54, v14
    s_add_u32 s54, s54, 4096
    s_sub_u32 s55, s54, 20480
    s_min_u32 s54, s54, s55
    v_add_u32 v230, s54, v14
    v_lshrrev_b32 v14, 4, v1
    v_bfe_u32 v15, v1, 2, 2
    v_lshl_add_u32 v14, v14, 3, v15
    v_mul_u32_u24 v14, 40, v14
    v_add_u32 v14, s79, v14
    v_and_b32 v15, 3, v1
    v_lshlrev_b32 v15, 4, v15
    v_min_u32 v238, 32, v15
    v_add_u32 v238, v238, v14
    v_add_u32 v15, 8, v15
    v_min_u32 v239, 32, v15
    v_add_u32 v239, v239, v14
    s_mul_i32 s54, s81, 2560
    s_add_u32 s54, s54, 143360
    v_add_u32 v245, s54, v2
    v_add_u32 v246, s54, v16
    s_add_u32 s55, s44, 153600
    v_mov_b32 v242, s55
    v_mov_b32 v13, 0
    s_mov_b64 exec, 1
    ds_write_b8 v242, v13
    s_mov_b64 exec, -1
    v_mov_b32 v13, 1
    s_bitcmp1_b32 s47, 0
    s_cbranch_scc1 L_ofv
    v_lshrrev_b32 v14, 4, v1
    v_and_b32 v15, 3, v1
    v_lshlrev_b32 v15, 4, v15
    v_lshl_add_u32 v240, v14, 9, v15
    v_and_b32 v15, 4, v1
    v_lshl_add_u32 v240, v15, 5, v240
    v_and_b32 v15, 8, v1
    v_lshl_add_u32 v240, v15, 3, v240
    s_and_b32 s55, s50, 1
    s_lshl_b32 s55, s55, 8
    s_mov_b32 exec_lo, 0
    v_subrev_u32 v240, s55, v240
    v_add_u32 v240, 1024, v240
    v_lshrrev_b32 v240, 1, v240
    s_mov_b32 exec_lo, -1
    s_branch L_ofd
L_ofv:
    v_and_b32 v14, 7, v1
    v_lshlrev_b32 v14, 2, v14
    v_mov_b32 v15, 0x73625410
    v_lshrrev_b32 v14, v14, v15
    v_and_b32 v14, 7, v14
    v_add_u32 v14, 16, v14
    v_and_b32 v15, 4, v1
    v_lshlrev_b32 v15, 1, v15
    v_and_b32 v241, 3, v1
    v_add_u32 v15, v15, v241
    v_lshrrev_b32 v241, 5, v1
    v_lshl_add_u32 v15, v241, 2, v15
    s_mov_b32 vcc_lo, 0xff00ff00
    s_mov_b32 vcc_hi, 0xff00ff00
    v_cndmask_b32 v14, v15, v14, vcc
    v_bfe_u32 v15, v1, 4, 1
    v_mul_u32_u24 v15, 384, v15
    v_lshl_add_u32 v240, v14, 4, v15
    s_and_b32 s55, s50, 1
    s_mul_i32 s55, s55, 768
    s_add_u32 s55, s55, 1536
L_ofd:
    s_lshl_b32 s54, s48, 13
    s_lshr_b32 s56, s50, 1
    s_lshl_b32 s56, s56, 12
    s_add_u32 s54, s54, s56
    s_add_u32 s54, s54, s55
    v_add_u32 v241, s79, v2
    s_waitcnt lgkmcnt(0)
    s_mul_i32 s51, s51, 1664525
    s_add_u32 s51, s51, 1013904223
    s_waitcnt vmcnt(0)
    s_barrier
    ds_read_b128 v[38:41], v237 offset:0
    ds_read_b64_tr_b16 v[98:99], v238 offset:0
    ds_read_b64_tr_b16 v[100:101], v238 offset:160
    ds_read_b64_tr_b16 v[102:103], v239 offset:0
    ds_read_b64_tr_b16 v[104:105], v239 offset:160
    ds_read_b128 v[42:45], v247 offset:0
    ds_read_b64_tr_b16 v[106:107], v238 offset:1280
    ds_read_b64_tr_b16 v[108:109], v238 offset:1440
    ds_read_b64_tr_b16 v[110:111], v239 offset:1280
    ds_read_b64_tr_b16 v[112:113], v239 offset:1440
    ds_read_b128 v[46:49], v237 offset:2048
    ds_read_b64_tr_b16 v[114:115], v238 offset:2560
    ds_read_b64_tr_b16 v[116:117], v238 offset:2720
    ds_read_b64_tr_b16 v[118:119], v239 offset:2560
    ds_read_b64_tr_b16 v[120:121], v239 offset:2720
    ds_read_b128 v[50:53], v247 offset:2048
    ds_read_b64_tr_b16 v[122:123], v238 offset:3840
    ds_read_b64_tr_b16 v[124:125], v238 offset:4000
    ds_read_b64_tr_b16 v[126:127], v239 offset:3840
    ds_read_b64_tr_b16 v[128:129], v239 offset:4000
    ds_read_b128 v[54:57], v237 offset:4096
    ds_read_b64_tr_b16 v[130:131], v238 offset:5120
    ds_read_b64_tr_b16 v[132:133], v238 offset:5280
    ds_read_b64_tr_b16 v[134:135], v239 offset:5120
    ds_read_b64_tr_b16 v[136:137], v239 offset:5280
    s_bitcmp1_b32 s47, 0
    s_cbranch_scc1 L_chv
    s_waitcnt lgkmcnt(15)
    v_mfma_f32_16x16x32_bf16 v[78:81], v[98:101], v[38:41], 0
    v_mfma_f32_16x16x32_bf16 v[82:85], v[102:105], v[38:41], 0
    v_mfma_f32_16x16x32_bf16 v[78:81], v[106:109], v[42:45], v[78:81]
    v_mfma_f32_16x16x32_bf16 v[82:85], v[110:113], v[42:45], v[82:85]
    s_waitcnt lgkmcnt(12)
    v_mfma_f32_16x16x32_bf16 v[78:81], v[114:117], v[46:49], v[78:81]
    s_waitcnt lgkmcnt(10)
    v_mfma_f32_16x16x32_bf16 v[82:85], v[118:121], v[46:49], v[82:85]
    s_waitcnt lgkmcnt(7)
    v_mfma_f32_16x16x32_bf16 v[78:81], v[122:125], v[50:53], v[78:81]
    s_waitcnt lgkmcnt(5)
    v_mfma_f32_16x16x32_bf16 v[82:85], v[126:129], v[50:53], v[82:85]
    s_waitcnt lgkmcnt(2)
    v_mfma_f32_16x16x32_bf16 v[78:81], v[130:133], v[54:57], v[78:81]
    s_waitcnt lgkmcnt(0)
    v_mfma_f32_16x16x32_bf16 v[82:85], v[134:137], v[54:57], v[82:85]
    s_branch L_chd
L_chv:
    s_waitcnt lgkmcnt(15)
    v_mfma_f32_16x16x32_bf16 v[78:81], v[38:41], v[98:101], 0
    v_mfma_f32_16x16x32_bf16 v[82:85], v[38:41], v[102:105], 0
    v_mfma_f32_16x16x32_bf16 v[78:81], v[42:45], v[106:109], v[78:81]
    v_mfma_f32_16x16x32_bf16 v[82:85], v[42:45], v[110:113], v[82:85]
    s_waitcnt lgkmcnt(12)
    v_mfma_f32_16x16x32_bf16 v[78:81], v[46:49], v[114:117], v[78:81]
    s_waitcnt lgkmcnt(10)
    v_mfma_f32_16x16x32_bf16 v[82:85], v[46:49], v[118:121], v[82:85]
    s_waitcnt lgkmcnt(7)
    v_mfma_f32_16x16x32_bf16 v[78:81], v[50:53], v[122:125], v[78:81]
    s_waitcnt lgkmcnt(5)
    v_mfma_f32_16x16x32_bf16 v[82:85], v[50:53], v[126:129], v[82:85]
    s_waitcnt lgkmcnt(2)
    v_mfma_f32_16x16x32_bf16 v[78:81], v[54:57], v[130:133], v[78:81]
    s_waitcnt lgkmcnt(0)
    v_mfma_f32_16x16x32_bf16 v[82:85], v[54:57], v[134:137], v[82:85]
L_chd:
    s_cmp_eq_u32 s44, 0
    s_cbranch_scc1 L_fin0
    s_nop 5
    ds_write_b128 v241, v[78:81]
    ds_write_b128 v241, v[82:85] offset:1024
    s_mov_b64 exec, 1
    ds_write_b8 v242, v13
    s_mov_b64 exec, -1
    s_branch L_bx
L_fin0:
    ds_read_b32 v162, v242
    ds_read_b128 v[138:141], v241 offset:6400
    ds_read_b128 v[142:145], v241 offset:7424
    ds_read_b128 v[146:149], v241 offset:12800
    ds_read_b128 v[150:153], v241 offset:13824
    ds_read_b128 v[154:157], v241 offset:19200
    ds_read_b128 v[158:161], v241 offset:20224
    s_add_u32 s64, s64, 1
    s_cmp_lt_u32 s64, 1000000
    s_cbranch_scc0 L_end
    s_waitcnt lgkmcnt(6)
    v_cmp_ne_u32 vcc, 0x01010100, v162
    s_waitcnt lgkmcnt(0)
    s_cbranch_vccnz L_fin0
    v_add_f32 v78, v78, v138
    v_add_f32 v146, v146, v154
    v_add_f32 v79, v79, v139
    v_add_f32 v147, v147, v155
    v_add_f32 v80, v80, v140
    v_add_f32 v148, v148, v156
    v_add_f32 v81, v81, v141
    v_add_f32 v149, v149, v157
    v_add_f32 v82, v82, v142
    v_add_f32 v150, v150, v158
    v_add_f32 v83, v83, v143
    v_add_f32 v151, v151, v159
    v_add_f32 v84, v84, v144
    v_add_f32 v152, v152, v160
    v_add_f32 v85, v85, v145
    v_add_f32 v153, v153, v161
    v_add_f32 v78, v78, v146
    v_add_f32 v79, v79, v147
    v_add_f32 v80, v80, v148
    v_add_f32 v81, v81, v149
    v_add_f32 v82, v82, v150
    v_add_f32 v83, v83, v151
    v_add_f32 v84, v84, v152
    v_add_f32 v85, v85, v153
    s_bitcmp1_b32 s47, 0
    s_cbranch_scc1 L_stv
    v_mul_f32 v78, 0x3ea52b5c, v78
    v_mul_f32 v79, 0x3ea52b5c, v79
    v_mul_f32 v80, 0x3ea52b5c, v80
    v_mul_f32 v81, 0x3ea52b5c, v81
    v_mul_f32 v82, 0x3ea52b5c, v82
    v_mul_f32 v83, 0x3ea52b5c, v83
    v_mul_f32 v84, 0x3ea52b5c, v84
    v_mul_f32 v85, 0x3ea52b5c, v85
    v_cvt_pk_bf16_f32 v138, v78, v79
    v_cvt_pk_bf16_f32 v139, v80, v81
    v_cvt_pk_bf16_f32 v140, v82, v83
    v_cvt_pk_bf16_f32 v141, v84, v85
    v_mov_b32_dpp v140, v138 quad_perm:[1,1,3,3] row_mask:0x4 bank_mask:0xf
    v_mov_b32_dpp v141, v139 quad_perm:[1,1,3,3] row_mask:0x4 bank_mask:0xf
    s_mov_b32 exec_hi, 0x5555
    s_branch L_std
L_stv:
    v_cvt_pk_bf16_f32 v138, v78, v79
    v_cvt_pk_bf16_f32 v139, v80, v81
    v_cvt_pk_bf16_f32 v140, v82, v83
    v_cvt_pk_bf16_f32 v141, v84, v85
    v_add_f32 v14, abs(v78), abs(v79)
    v_add_f32 v14, v14, abs(v80)
    v_add_f32 v14, v14, abs(v81)
    v_add_f32 v14, v14, abs(v82)
    v_add_f32 v14, v14, abs(v83)
    v_add_f32 v14, v14, abs(v84)
    v_add_f32 v14, v14, abs(v85)
    v_permlane32_swap_b32 v138, v140
    v_permlane32_swap_b32 v139, v141
    v_cmp_nge_f32 vcc, 0x5c000000, v14
    s_mov_b32 s55, 0x3f803f80
    s_nop 0
    s_cmp_lg_u64 vcc, 0
    s_cselect_b32 s55, 0x7f807f80, s55
    s_mov_b64 exec, 0x30003000
    v_mov_b32 v138, s55
    v_mov_b32 v139, s55
    v_mov_b32 v140, s55
    v_mov_b32 v141, s55
    s_mov_b32 exec_lo, 0xc000c000
    v_mov_b32 v138, 0
    v_mov_b32 v139, 0
    v_mov_b32 v140, 0
    v_mov_b32 v141, 0
    s_mov_b32 exec_lo, -1
    s_mov_b32 exec_hi, 0x00ff00ff
L_std:
    buffer_store_dwordx4 v[138:141], v240, s[40:43], s54 offen sc1
    s_mov_b64 exec, -1
    s_lshl_b32 s3, s48, 3
    s_add_u32 s3, s3, s47
    s_lshl_b32 s3, s3, 7
    s_add_u32 s3, s3, 262144
    v_mov_b32 v15, s51
L_bx:
    s_barrier
    ds_read_b128 v[38:41], v226 offset:0
    ds_read_b128 v[46:49], v226 offset:2048
    v_xor_b32 v226, 64, v226
    ds_read_b128 v[54:57], v227 offset:0
    ds_read_b128 v[62:65], v227 offset:2048
    v_xor_b32 v227, 64, v227
    ds_read_b128 v[70:73], v228 offset:0
    ds_read_b128 v[78:81], v228 offset:2048
    v_xor_b32 v228, 64, v228
    ds_read_b128 v[86:89], v229 offset:0
    ds_read_b128 v[94:97], v229 offset:2048
    v_xor_b32 v229, 64, v229
    ds_read_b128 v[102:105], v230 offset:0
    ds_read_b128 v[110:113], v230 offset:2048
    v_xor_b32 v230, 64, v230
    ds_read_b128 v[42:45], v226 offset:0
    ds_read_b128 v[50:53], v226 offset:2048
    ds_read_b128 v[58:61], v227 offset:0
    ds_read_b128 v[66:69], v227 offset:2048
    ds_read_b128 v[74:77], v228 offset:0
    ds_read_b128 v[82:85], v228 offset:2048
    ds_read_b128 v[90:93], v229 offset:0
    ds_read_b128 v[98:101], v229 offset:2048
    ds_read_b128 v[106:109], v230 offset:0
    ds_read_b128 v[114:117], v230 offset:2048
    s_waitcnt lgkmcnt(0)
    s_barrier
    ds_read_b64_tr_b16 v[138:139], v244 offset:0
    ds_read_b64_tr_b16 v[140:141], v244 offset:2560
    ds_read_b64_tr_b16 v[142:143], v244 offset:8
    ds_read_b64_tr_b16 v[144:145], v244 offset:2568
    ds_read_b64_tr_b16 v[146:147], v244 offset:16
    ds_read_b64_tr_b16 v[148:149], v244 offset:2576
    ds_read_b64_tr_b16 v[150:151], v244 offset:24
    ds_read_b64_tr_b16 v[152:153], v244 offset:2584
    ds_read_b64_tr_b16 v[154:155], v244 offset:32
    ds_read_b64_tr_b16 v[156:157], v244 offset:2592
    ds_read_b64_tr_b16 v[158:159], v244 offset:5120
    ds_read_b64_tr_b16 v[160:161], v244 offset:7680
    ds_read_b64_tr_b16 v[162:163], v244 offset:5128
    ds_read_b64_tr_b16 v[164:165], v244 offset:7688
    s_waitcnt lgkmcnt(12)
    v_mfma_f32_16x16x32_bf16 v[118:121], v[138:141], v[38:41], 0
    ds_read_b64_tr_b16 v[166:167], v244 offset:5136
    ds_read_b64_tr_b16 v[168:169], v244 offset:7696
    s_waitcnt lgkmcnt(12)
    v_mfma_f32_16x16x32_bf16 v[122:125], v[142:145], v[38:41], 0
    ds_read_b64_tr_b16 v[170:171], v244 offset:5144
    ds_read_b64_tr_b16 v[172:173], v244 offset:7704
    s_waitcnt lgkmcnt(12)
    v_mfma_f32_16x16x32_bf16 v[126:129], v[146:149], v[38:41], 0
    ds_read_b64_tr_b16 v[174:175], v244 offset:5152
    ds_read_b64_tr_b16 v[176:177], v244 offset:7712
    s_waitcnt lgkmcnt(12)
    v_mfma_f32_16x16x32_bf16 v[130:133], v[150:153], v[38:41], 0
    s_cmp_eq_u32 s44, 0
    s_cbranch_scc0 L_pubd
    s_mov_b64 exec, 1
    s_waitcnt vmcnt(0)
    buffer_store_dword v15, v2, s[40:43], s3 offen sc1
    s_mov_b64 exec, -1
L_pubd:
    s_barrier
    ds_read_b64_tr_b16 v[178:179], v244 offset:10240
    ds_read_b64_tr_b16 v[180:181], v244 offset:12800
    s_waitcnt lgkmcnt(12)
    v_mfma_f32_16x16x32_bf16 v[134:137], v[154:157], v[38:41], 0
    ds_read_b64_tr_b16 v[138:139], v244 offset:10248
    ds_read_b64_tr_b16 v[140:141], v244 offset:12808
    s_waitcnt lgkmcnt(12)
    v_mfma_f32_16x16x32_bf16 v[118:121], v[158:161], v[42:45], v[118:121]
    ds_read_b64_tr_b16 v[142:143], v244 offset:10256
    ds_read_b64_tr_b16 v[144:145], v244 offset:12816
    s_waitcnt lgkmcnt(12)
    v_mfma_f32_16x16x32_bf16 v[122:125], v[162:165], v[42:45], v[122:125]
    ds_read_b64_tr_b16 v[146:147], v244 offset:10264
    ds_read_b64_tr_b16 v[148:149], v244 offset:12824
    s_waitcnt lgkmcnt(12)
    v_mfma_f32_16x16x32_bf16 v[126:129], v[166:169], v[42:45], v[126:129]
    ds_read_b64_tr_b16 v[150:151], v244 offset:10272
    ds_read_b64_tr_b16 v[152:153], v244 offset:12832
    s_waitcnt lgkmcnt(12)
    v_mfma_f32_16x16x32_bf16 v[130:133], v[170:173], v[42:45], v[130:133]
    ds_read_b64_tr_b16 v[154:155], v244 offset:15360
    ds_read_b64_tr_b16 v[156:157], v244 offset:17920
    s_waitcnt lgkmcnt(12)
    v_mfma_f32_16x16x32_bf16 v[134:137], v[174:177], v[42:45], v[134:137]
    ds_read_b64_tr_b16 v[158:159], v244 offset:15368
    ds_read_b64_tr_b16 v[160:161], v244 offset:17928
    s_waitcnt lgkmcnt(12)
    v_mfma_f32_16x16x32_bf16 v[118:121], v[178:181], v[46:49], v[118:121]
    ds_read_b64_tr_b16 v[162:163], v244 offset:15376
    ds_read_b64_tr_b16 v[164:165], v244 offset:17936
    s_waitcnt lgkmcnt(12)
    v_mfma_f32_16x16x32_bf16 v[122:125], v[138:141], v[46:49], v[122:125]
    ds_read_b64_tr_b16 v[166:167], v244 offset:15384
    ds_read_b64_tr_b16 v[168:169], v244 offset:17944
    s_waitcnt lgkmcnt(12)
    v_mfma_f32_16x16x32_bf16 v[126:129], v[142:145], v[46:49], v[126:129]
    ds_read_b64_tr_b16 v[170:171], v244 offset:15392
    ds_read_b64_tr_b16 v[172:173], v244 offset:17952
    s_waitcnt lgkmcnt(12)
    v_mfma_f32_16x16x32_bf16 v[130:133], v[146:149], v[46:49], v[130:133]
    s_barrier
    ds_read_b64_tr_b16 v[174:175], v244 offset:20480
    ds_read_b64_tr_b16 v[176:177], v244 offset:23040
    s_waitcnt lgkmcnt(12)
    v_mfma_f32_16x16x32_bf16 v[134:137], v[150:153], v[46:49], v[134:137]
    ds_read_b64_tr_b16 v[178:179], v244 offset:20488
    ds_read_b64_tr_b16 v[180:181], v244 offset:23048
    s_waitcnt lgkmcnt(12)
    v_mfma_f32_16x16x32_bf16 v[118:121], v[154:157], v[50:53], v[118:121]
    ds_read_b64_tr_b16 v[138:139], v244 offset:20496
    ds_read_b64_tr_b16 v[140:141], v244 offset:23056
    s_waitcnt lgkmcnt(12)
    v_mfma_f32_16x16x32_bf16 v[122:125], v[158:161], v[50:53], v[122:125]
    ds_read_b64_tr_b16 v[142:143], v244 offset:20504
    ds_read_b64_tr_b16 v[144:145], v244 offset:23064
    s_waitcnt lgkmcnt(12)
    v_mfma_f32_16x16x32_bf16 v[126:129], v[162:165], v[50:53], v[126:129]
    ds_read_b64_tr_b16 v[146:147], v244 offset:20512
    ds_read_b64_tr_b16 v[148:149], v244 offset:23072
    s_waitcnt lgkmcnt(12)
    v_mfma_f32_16x16x32_bf16 v[130:133], v[166:169], v[50:53], v[130:133]
    ds_read_b64_tr_b16 v[150:151], v244 offset:25600
    ds_read_b64_tr_b16 v[152:153], v244 offset:28160
    s_waitcnt lgkmcnt(12)
    v_mfma_f32_16x16x32_bf16 v[134:137], v[170:173], v[50:53], v[134:137]
    ds_read_b64_tr_b16 v[154:155], v244 offset:25608
    ds_read_b64_tr_b16 v[156:157], v244 offset:28168
    s_waitcnt lgkmcnt(12)
    v_mfma_f32_16x16x32_bf16 v[118:121], v[174:177], v[54:57], v[118:121]
    ds_read_b64_tr_b16 v[158:159], v244 offset:25616
    ds_read_b64_tr_b16 v[160:161], v244 offset:28176
    s_waitcnt lgkmcnt(12)
    v_mfma_f32_16x16x32_bf16 v[122:125], v[178:181], v[54:57], v[122:125]
    ds_read_b64_tr_b16 v[162:163], v244 offset:25624
    ds_read_b64_tr_b16 v[164:165], v244 offset:28184
    s_waitcnt lgkmcnt(12)
    v_mfma_f32_16x16x32_bf16 v[126:129], v[138:141], v[54:57], v[126:129]
    ds_read_b64_tr_b16 v[166:167], v244 offset:25632
    ds_read_b64_tr_b16 v[168:169], v244 offset:28192
    s_waitcnt lgkmcnt(12)
    v_mfma_f32_16x16x32_bf16 v[130:133], v[142:145], v[54:57], v[130:133]
    s_barrier
    ds_read_b64_tr_b16 v[170:171], v244 offset:30720
    ds_read_b64_tr_b16 v[172:173], v244 offset:33280
    s_waitcnt lgkmcnt(12)
    v_mfma_f32_16x16x32_bf16 v[134:137], v[146:149], v[54:57], v[134:137]
    ds_read_b64_tr_b16 v[174:175], v244 offset:30728
    ds_read_b64_tr_b16 v[176:177], v244 offset:33288
    s_waitcnt lgkmcnt(12)
    v_mfma_f32_16x16x32_bf16 v[118:121], v[150:153], v[58:61], v[118:121]
    ds_read_b64_tr_b16 v[178:179], v244 offset:30736
    ds_read_b64_tr_b16 v[180:181], v244 offset:33296
    s_waitcnt lgkmcnt(12)
    v_mfma_f32_16x16x32_bf16 v[122:125], v[154:157], v[58:61], v[122:125]
    ds_read_b64_tr_b16 v[138:139], v244 offset:30744
    ds_read_b64_tr_b16 v[140:141], v244 offset:33304
    s_waitcnt lgkmcnt(12)
    v_mfma_f32_16x16x32_bf16 v[126:129], v[158:161], v[58:61], v[126:129]
    ds_read_b64_tr_b16 v[142:143], v244 offset:30752
    ds_read_b64_tr_b16 v[144:145], v244 offset:33312
    s_waitcnt lgkmcnt(12)
    v_mfma_f32_16x16x32_bf16 v[130:133], v[162:165], v[58:61], v[130:133]
    ds_read_b64_tr_b16 v[146:147], v244 offset:35840
    ds_read_b64_tr_b16 v[148:149], v244 offset:38400
    s_waitcnt lgkmcnt(12)
    v_mfma_f32_16x16x32_bf16 v[134:137], v[166:169], v[58:61], v[134:137]
    ds_read_b64_tr_b16 v[150:151], v244 offset:35848
    ds_read_b64_tr_b16 v[152:153], v244 offset:38408
    s_waitcnt lgkmcnt(12)
    v_mfma_f32_16x16x32_bf16 v[118:121], v[170:173], v[62:65], v[118:121]
    ds_read_b64_tr_b16 v[154:155], v244 offset:35856
    ds_read_b64_tr_b16 v[156:157], v244 offset:38416
    s_waitcnt lgkmcnt(12)
    v_mfma_f32_16x16x32_bf16 v[122:125], v[174:177], v[62:65], v[122:125]
    ds_read_b64_tr_b16 v[158:159], v244 offset:35864
    ds_read_b64_tr_b16 v[160:161], v244 offset:38424
    s_waitcnt lgkmcnt(12)
    v_mfma_f32_16x16x32_bf16 v[126:129], v[178:181], v[62:65], v[126:129]
    ds_read_b64_tr_b16 v[162:163], v244 offset:35872
    ds_read_b64_tr_b16 v[164:165], v244 offset:38432
    s_waitcnt lgkmcnt(12)
    v_mfma_f32_16x16x32_bf16 v[130:133], v[138:141], v[62:65], v[130:133]
    s_barrier
    ds_read_b64_tr_b16 v[166:167], v244 offset:40960
    ds_read_b64_tr_b16 v[168:169], v244 offset:43520
    s_waitcnt lgkmcnt(12)
    v_mfma_f32_16x16x32_bf16 v[134:137], v[142:145], v[62:65], v[134:137]
    ds_read_b64_tr_b16 v[170:171], v244 offset:40968
    ds_read_b64_tr_b16 v[172:173], v244 offset:43528
    s_waitcnt lgkmcnt(12)
    v_mfma_f32_16x16x32_bf16 v[118:121], v[146:149], v[66:69], v[118:121]
    ds_read_b64_tr_b16 v[174:175], v244 offset:40976
    ds_read_b64_tr_b16 v[176:177], v244 offset:43536
    s_waitcnt lgkmcnt(12)
    v_mfma_f32_16x16x32_bf16 v[122:125], v[150:153], v[66:69], v[122:125]
    ds_read_b64_tr_b16 v[178:179], v244 offset:40984
    ds_read_b64_tr_b16 v[180:181], v244 offset:43544
    s_waitcnt lgkmcnt(12)
    v_mfma_f32_16x16x32_bf16 v[126:129], v[154:157], v[66:69], v[126:129]
    ds_read_b64_tr_b16 v[138:139], v244 offset:40992
    ds_read_b64_tr_b16 v[140:141], v244 offset:43552
    s_waitcnt lgkmcnt(12)
    v_mfma_f32_16x16x32_bf16 v[130:133], v[158:161], v[66:69], v[130:133]
    ds_read_b64_tr_b16 v[142:143], v244 offset:46080
    ds_read_b64_tr_b16 v[144:145], v244 offset:48640
    s_waitcnt lgkmcnt(12)
    v_mfma_f32_16x16x32_bf16 v[134:137], v[162:165], v[66:69], v[134:137]
    ds_read_b64_tr_b16 v[146:147], v244 offset:46088
    ds_read_b64_tr_b16 v[148:149], v244 offset:48648
    s_waitcnt lgkmcnt(12)
    v_mfma_f32_16x16x32_bf16 v[118:121], v[166:169], v[70:73], v[118:121]
    ds_read_b64_tr_b16 v[150:151], v244 offset:46096
    ds_read_b64_tr_b16 v[152:153], v244 offset:48656
    s_waitcnt lgkmcnt(12)
    v_mfma_f32_16x16x32_bf16 v[122:125], v[170:173], v[70:73], v[122:125]
    ds_read_b64_tr_b16 v[154:155], v244 offset:46104
    ds_read_b64_tr_b16 v[156:157], v244 offset:48664
    s_waitcnt lgkmcnt(12)
    v_mfma_f32_16x16x32_bf16 v[126:129], v[174:177], v[70:73], v[126:129]
    ds_read_b64_tr_b16 v[158:159], v244 offset:46112
    ds_read_b64_tr_b16 v[160:161], v244 offset:48672
    s_waitcnt lgkmcnt(12)
    v_mfma_f32_16x16x32_bf16 v[130:133], v[178:181], v[70:73], v[130:133]
    s_barrier
    ds_read_b64_tr_b16 v[162:163], v244 offset:51200
    ds_read_b64_tr_b16 v[164:165], v244 offset:53760
    s_waitcnt lgkmcnt(12)
    v_mfma_f32_16x16x32_bf16 v[134:137], v[138:141], v[70:73], v[134:137]
    ds_read_b64_tr_b16 v[166:167], v244 offset:51208
    ds_read_b64_tr_b16 v[168:169], v244 offset:53768
    s_waitcnt lgkmcnt(12)
    v_mfma_f32_16x16x32_bf16 v[118:121], v[142:145], v[74:77], v[118:121]
    ds_read_b64_tr_b16 v[170:171], v244 offset:51216
    ds_read_b64_tr_b16 v[172:173], v244 offset:53776
    s_waitcnt lgkmcnt(12)
    v_mfma_f32_16x16x32_bf16 v[122:125], v[146:149], v[74:77], v[122:125]
    ds_read_b64_tr_b16 v[174:175], v244 offset:51224
    ds_read_b64_tr_b16 v[176:177], v244 offset:53784
    s_waitcnt lgkmcnt(12)
    v_mfma_f32_16x16x32_bf16 v[126:129], v[150:153], v[74:77], v[126:129]
    ds_read_b64_tr_b16 v[178:179], v244 offset:51232
    ds_read_b64_tr_b16 v[180:181], v244 offset:53792
    s_waitcnt lgkmcnt(12)
    v_mfma_f32_16x16x32_bf16 v[130:133], v[154:157], v[74:77], v[130:133]
    ds_read_b64_tr_b16 v[138:139], v244 offset:56320
    ds_read_b64_tr_b16 v[140:141], v244 offset:58880
    s_waitcnt lgkmcnt(12)
    v_mfma_f32_16x16x32_bf16 v[134:137], v[158:161], v[74:77], v[134:137]
    ds_read_b64_tr_b16 v[142:143], v244 offset:56328
    ds_read_b64_tr_b16 v[144:145], v244 offset:58888
    s_waitcnt lgkmcnt(12)
    v_mfma_f32_16x16x32_bf16 v[118:121], v[162:165], v[78:81], v[118:121]
    ds_read_b64_tr_b16 v[146:147], v244 offset:56336
    ds_read_b64_tr_b16 v[148:149], v244 offset:58896
    s_waitcnt lgkmcnt(12)
    v_mfma_f32_16x16x32_bf16 v[122:125], v[166:169], v[78:81], v[122:125]
    ds_read_b64_tr_b16 v[150:151], v244 offset:56344
    ds_read_b64_tr_b16 v[152:153], v244 offset:58904
    s_waitcnt lgkmcnt(12)
    v_mfma_f32_16x16x32_bf16 v[126:129], v[170:173], v[78:81], v[126:129]
    ds_read_b64_tr_b16 v[154:155], v244 offset:56352
    ds_read_b64_tr_b16 v[156:157], v244 offset:58912
    s_waitcnt lgkmcnt(12)
    v_mfma_f32_16x16x32_bf16 v[130:133], v[174:177], v[78:81], v[130:133]
    s_barrier
    ds_read_b64_tr_b16 v[158:159], v243 offset:0
    ds_read_b64_tr_b16 v[160:161], v243 offset:2560
    s_waitcnt lgkmcnt(12)
    v_mfma_f32_16x16x32_bf16 v[134:137], v[178:181], v[78:81], v[134:137]
    ds_read_b64_tr_b16 v[162:163], v243 offset:8
    ds_read_b64_tr_b16 v[164:165], v243 offset:2568
    s_waitcnt lgkmcnt(12)
    v_mfma_f32_16x16x32_bf16 v[118:121], v[138:141], v[82:85], v[118:121]
    ds_read_b64_tr_b16 v[166:167], v243 offset:16
    ds_read_b64_tr_b16 v[168:169], v243 offset:2576
    s_waitcnt lgkmcnt(12)
    v_mfma_f32_16x16x32_bf16 v[122:125], v[142:145], v[82:85], v[122:125]
    ds_read_b64_tr_b16 v[170:171], v243 offset:24
    ds_read_b64_tr_b16 v[172:173], v243 offset:2584
    s_waitcnt lgkmcnt(12)
    v_mfma_f32_16x16x32_bf16 v[126:129], v[146:149], v[82:85], v[126:129]
    ds_read_b64_tr_b16 v[174:175], v243 offset:32
    ds_read_b64_tr_b16 v[176:177], v243 offset:2592
    s_waitcnt lgkmcnt(12)
    v_mfma_f32_16x16x32_bf16 v[130:133], v[150:153], v[82:85], v[130:133]
    ds_read_b64_tr_b16 v[178:179], v243 offset:5120
    ds_read_b64_tr_b16 v[180:181], v243 offset:7680
    s_waitcnt lgkmcnt(12)
    v_mfma_f32_16x16x32_bf16 v[134:137], v[154:157], v[82:85], v[134:137]
    ds_read_b64_tr_b16 v[138:139], v243 offset:5128
    ds_read_b64_tr_b16 v[140:141], v243 offset:7688
    s_waitcnt lgkmcnt(12)
    v_mfma_f32_16x16x32_bf16 v[118:121], v[158:161], v[86:89], v[118:121]
    ds_read_b64_tr_b16 v[142:143], v243 offset:5136
    ds_read_b64_tr_b16 v[144:145], v243 offset:7696
    s_waitcnt lgkmcnt(12)
    v_mfma_f32_16x16x32_bf16 v[122:125], v[162:165], v[86:89], v[122:125]
    ds_read_b64_tr_b16 v[146:147], v243 offset:5144
    ds_read_b64_tr_b16 v[148:149], v243 offset:7704
    s_waitcnt lgkmcnt(12)
    v_mfma_f32_16x16x32_bf16 v[126:129], v[166:169], v[86:89], v[126:129]
    ds_read_b64_tr_b16 v[150:151], v243 offset:5152
    ds_read_b64_tr_b16 v[152:153], v243 offset:7712
    s_waitcnt lgkmcnt(12)
    v_mfma_f32_16x16x32_bf16 v[130:133], v[170:173], v[86:89], v[130:133]
    s_barrier
    ds_read_b64_tr_b16 v[154:155], v243 offset:10240
    ds_read_b64_tr_b16 v[156:157], v243 offset:12800
    s_waitcnt lgkmcnt(12)
    v_mfma_f32_16x16x32_bf16 v[134:137], v[174:177], v[86:89], v[134:137]
    ds_read_b64_tr_b16 v[158:159], v243 offset:10248
    ds_read_b64_tr_b16 v[160:161], v243 offset:12808
    s_waitcnt lgkmcnt(12)
    v_mfma_f32_16x16x32_bf16 v[118:121], v[178:181], v[90:93], v[118:121]
    ds_read_b64_tr_b16 v[162:163], v243 offset:10256
    ds_read_b64_tr_b16 v[164:165], v243 offset:12816
    s_waitcnt lgkmcnt(12)
    v_mfma_f32_16x16x32_bf16 v[122:125], v[138:141], v[90:93], v[122:125]
    ds_read_b64_tr_b16 v[166:167], v243 offset:10264
    ds_read_b64_tr_b16 v[168:169], v243 offset:12824
    s_waitcnt lgkmcnt(12)
    v_mfma_f32_16x16x32_bf16 v[126:129], v[142:145], v[90:93], v[126:129]
    ds_read_b64_tr_b16 v[170:171], v243 offset:10272
    ds_read_b64_tr_b16 v[172:173], v243 offset:12832
    s_waitcnt lgkmcnt(12)
    v_mfma_f32_16x16x32_bf16 v[130:133], v[146:149], v[90:93], v[130:133]
    ds_read_b64_tr_b16 v[174:175], v243 offset:15360
    ds_read_b64_tr_b16 v[176:177], v243 offset:17920
    s_waitcnt lgkmcnt(12)
    v_mfma_f32_16x16x32_bf16 v[134:137], v[150:153], v[90:93], v[134:137]
    ds_read_b64_tr_b16 v[178:179], v243 offset:15368
    ds_read_b64_tr_b16 v[180:181], v243 offset:17928
    s_waitcnt lgkmcnt(12)
    v_mfma_f32_16x16x32_bf16 v[118:121], v[154:157], v[94:97], v[118:121]
    ds_read_b64_tr_b16 v[138:139], v243 offset:15376
    ds_read_b64_tr_b16 v[140:141], v243 offset:17936
    s_waitcnt lgkmcnt(12)
    v_mfma_f32_16x16x32_bf16 v[122:125], v[158:161], v[94:97], v[122:125]
    ds_read_b64_tr_b16 v[142:143], v243 offset:15384
    ds_read_b64_tr_b16 v[144:145], v243 offset:17944
    s_waitcnt lgkmcnt(12)
    v_mfma_f32_16x16x32_bf16 v[126:129], v[162:165], v[94:97], v[126:129]
    ds_read_b64_tr_b16 v[146:147], v243 offset:15392
    ds_read_b64_tr_b16 v[148:149], v243 offset:17952
    s_waitcnt lgkmcnt(12)
    v_mfma_f32_16x16x32_bf16 v[130:133], v[166:169], v[94:97], v[130:133]
    s_barrier
    ds_read_b64_tr_b16 v[150:151], v243 offset:20480
    ds_read_b64_tr_b16 v[152:153], v243 offset:23040
    s_waitcnt lgkmcnt(12)
    v_mfma_f32_16x16x32_bf16 v[134:137], v[170:173], v[94:97], v[134:137]
    ds_read_b64_tr_b16 v[154:155], v243 offset:20488
    ds_read_b64_tr_b16 v[156:157], v243 offset:23048
    s_waitcnt lgkmcnt(12)
    v_mfma_f32_16x16x32_bf16 v[118:121], v[174:177], v[98:101], v[118:121]
    ds_read_b64_tr_b16 v[158:159], v243 offset:20496
    ds_read_b64_tr_b16 v[160:161], v243 offset:23056
    s_waitcnt lgkmcnt(12)
    v_mfma_f32_16x16x32_bf16 v[122:125], v[178:181], v[98:101], v[122:125]
    ds_read_b64_tr_b16 v[162:163], v243 offset:20504
    ds_read_b64_tr_b16 v[164:165], v243 offset:23064
    s_waitcnt lgkmcnt(12)
    v_mfma_f32_16x16x32_bf16 v[126:129], v[138:141], v[98:101], v[126:129]
    ds_read_b64_tr_b16 v[166:167], v243 offset:20512
    ds_read_b64_tr_b16 v[168:169], v243 offset:23072
    s_waitcnt lgkmcnt(12)
    v_mfma_f32_16x16x32_bf16 v[130:133], v[142:145], v[98:101], v[130:133]
    ds_read_b64_tr_b16 v[170:171], v243 offset:25600
    ds_read_b64_tr_b16 v[172:173], v243 offset:28160
    s_waitcnt lgkmcnt(12)
    v_mfma_f32_16x16x32_bf16 v[134:137], v[146:149], v[98:101], v[134:137]
    ds_read_b64_tr_b16 v[174:175], v243 offset:25608
    ds_read_b64_tr_b16 v[176:177], v243 offset:28168
    s_waitcnt lgkmcnt(12)
    v_mfma_f32_16x16x32_bf16 v[118:121], v[150:153], v[102:105], v[118:121]
    ds_read_b64_tr_b16 v[178:179], v243 offset:25616
    ds_read_b64_tr_b16 v[180:181], v243 offset:28176
    s_waitcnt lgkmcnt(12)
    v_mfma_f32_16x16x32_bf16 v[122:125], v[154:157], v[102:105], v[122:125]
    ds_read_b64_tr_b16 v[138:139], v243 offset:25624
    ds_read_b64_tr_b16 v[140:141], v243 offset:28184
    s_waitcnt lgkmcnt(12)
    v_mfma_f32_16x16x32_bf16 v[126:129], v[158:161], v[102:105], v[126:129]
    ds_read_b64_tr_b16 v[142:143], v243 offset:25632
    ds_read_b64_tr_b16 v[144:145], v243 offset:28192
    s_waitcnt lgkmcnt(12)
    v_mfma_f32_16x16x32_bf16 v[130:133], v[162:165], v[102:105], v[130:133]
    s_barrier
    ds_read_b64_tr_b16 v[146:147], v243 offset:30720
    ds_read_b64_tr_b16 v[148:149], v243 offset:33280
    s_waitcnt lgkmcnt(12)
    v_mfma_f32_16x16x32_bf16 v[134:137], v[166:169], v[102:105], v[134:137]
    ds_read_b64_tr_b16 v[150:151], v243 offset:30728
    ds_read_b64_tr_b16 v[152:153], v243 offset:33288
    s_waitcnt lgkmcnt(12)
    v_mfma_f32_16x16x32_bf16 v[118:121], v[170:173], v[106:109], v[118:121]
    ds_read_b64_tr_b16 v[154:155], v243 offset:30736
    ds_read_b64_tr_b16 v[156:157], v243 offset:33296
    s_waitcnt lgkmcnt(12)
    v_mfma_f32_16x16x32_bf16 v[122:125], v[174:177], v[106:109], v[122:125]
    ds_read_b64_tr_b16 v[158:159], v243 offset:30744
    ds_read_b64_tr_b16 v[160:161], v243 offset:33304
    s_waitcnt lgkmcnt(12)
    v_mfma_f32_16x16x32_bf16 v[126:129], v[178:181], v[106:109], v[126:129]
    ds_read_b64_tr_b16 v[162:163], v243 offset:30752
    ds_read_b64_tr_b16 v[164:165], v243 offset:33312
    s_waitcnt lgkmcnt(12)
    v_mfma_f32_16x16x32_bf16 v[130:133], v[138:141], v[106:109], v[130:133]
    ds_read_b64_tr_b16 v[166:167], v243 offset:35840
    ds_read_b64_tr_b16 v[168:169], v243 offset:38400
    s_waitcnt lgkmcnt(12)
    v_mfma_f32_16x16x32_bf16 v[134:137], v[142:145], v[106:109], v[134:137]
    ds_read_b64_tr_b16 v[170:171], v243 offset:35848
    ds_read_b64_tr_b16 v[172:173], v243 offset:38408
    s_waitcnt lgkmcnt(12)
    v_mfma_f32_16x16x32_bf16 v[118:121], v[146:149], v[110:113], v[118:121]
    ds_read_b64_tr_b16 v[174:175], v243 offset:35856
    ds_read_b64_tr_b16 v[176:177], v243 offset:38416
    s_waitcnt lgkmcnt(12)
    v_mfma_f32_16x16x32_bf16 v[122:125], v[150:153], v[110:113], v[122:125]
    ds_read_b64_tr_b16 v[178:179], v243 offset:35864
    ds_read_b64_tr_b16 v[180:181], v243 offset:38424
    s_waitcnt lgkmcnt(12)
    v_mfma_f32_16x16x32_bf16 v[126:129], v[154:157], v[110:113], v[126:129]
    ds_read_b64_tr_b16 v[138:139], v243 offset:35872
    ds_read_b64_tr_b16 v[140:141], v243 offset:38432
    s_waitcnt lgkmcnt(12)
    v_mfma_f32_16x16x32_bf16 v[130:133], v[158:161], v[110:113], v[130:133]
    s_waitcnt lgkmcnt(10)
    v_mfma_f32_16x16x32_bf16 v[134:137], v[162:165], v[110:113], v[134:137]
    s_waitcnt lgkmcnt(8)
    v_mfma_f32_16x16x32_bf16 v[118:121], v[166:169], v[114:117], v[118:121]
    s_waitcnt lgkmcnt(6)
    v_mfma_f32_16x16x32_bf16 v[122:125], v[170:173], v[114:117], v[122:125]
    s_waitcnt lgkmcnt(4)
    v_mfma_f32_16x16x32_bf16 v[126:129], v[174:177], v[114:117], v[126:129]
    s_waitcnt lgkmcnt(2)
    v_mfma_f32_16x16x32_bf16 v[130:133], v[178:181], v[114:117], v[130:133]
    s_waitcnt lgkmcnt(0)
    v_mfma_f32_16x16x32_bf16 v[134:137], v[138:141], v[114:117], v[134:137]
    v_mov_b32 v102, 0
    v_mov_b32 v103, 0
    v_mov_b32 v104, 0xdddddddd
    s_nop 0
    v_cvt_pk_bf16_f32 v38, v118, v119
    v_cvt_pk_bf16_f32 v39, v120, v121
    v_cvt_pk_bf16_f32 v40, v122, v123
    v_cvt_pk_bf16_f32 v41, v124, v125
    ds_write_b128 v245, v[38:41]
    v_cvt_pk_bf16_f32 v42, v126, v127
    v_cvt_pk_bf16_f32 v43, v128, v129
    v_cvt_pk_bf16_f32 v44, v130, v131
    v_cvt_pk_bf16_f32 v45, v132, v133
    ds_write_b128 v245, v[42:45] offset:1024
    v_cvt_pk_bf16_f32 v46, v134, v135
    v_cvt_pk_bf16_f32 v47, v136, v137
    ds_write_b64 v246, v[46:47] offset:2048
    v_mfma_f32_32x32x4_2b_bf16 v[118:149], v[102:103], v[102:103], 0
    v_mfma_f32_32x32x4_2b_bf16 v[150:181], v[102:103], v[102:103], 0
    s_waitcnt lgkmcnt(0)
    s_barrier
    buffer_load_dwordx4 v[182:185], v2, s[40:43], s58 offen
    buffer_load_dwordx2 v[186:187], v3, s[40:43], s58 offen offset:1024
    buffer_load_dwordx4 v[200:203], v4, s[40:43], s58 offen offset:1536
    buffer_load_dwordx4 v[204:207], v4, s[40:43], s58 offen offset:2304
    s_add_u32 s58, s58, 4096
    buffer_load_dwordx4 v[188:191], v2, s[40:43], s58 offen
L_bq:
    ds_read_b64 v[34:35], v235 offset:2048
    ds_read_b128 v[18:21], v231
    ds_read_b128 v[22:25], v232
    ds_read_b64 v[36:37], v236 offset:2048
    ds_read_b128 v[26:29], v233
    ds_read_b128 v[30:33], v234
    s_not_b32 s54, s51
    v_mov_b32 v13, s54
    s_mov_b64 exec, 0xffff
    ds_read_b32 v13, v248
    s_mov_b64 exec, -1
    s_waitcnt vmcnt(3)
    s_waitcnt lgkmcnt(6)
    v_mfma_f32_32x32x4_2b_bf16 v[38:69], v[186:187], v[34:35], 0 cbsz:1 abid:0
    v_mov_b32 v224, -1
    v_mov_b32 v225, -1
    v_mov_b32 v226, -1
    v_mov_b32 v227, -1
    s_xor_b32 s54, s51, s59
    v_mov_b32 v228, s54
    s_cmp_lg_u32 s82, 0
    s_cselect_b64 vcc, -1, 0
    s_nop 8
    s_waitcnt lgkmcnt(4)
    v_mfma_f32_32x32x16_bf16 v[38:53], v[182:185], v[18:21], v[38:53]
    v_mfma_f32_32x32x16_bf16 v[54:69], v[182:185], v[22:25], v[54:69]
    buffer_load_dwordx4 v[208:211], v4, s[40:43], s58 offen offset:1536
    buffer_load_dwordx4 v[212:215], v4, s[40:43], s58 offen offset:2304
    s_add_u32 s58, s58, 28672
    s_and_b32 s58, s58, 0x3ffff
    s_waitcnt lgkmcnt(0)
    s_setprio 3
    v_exp_f32 v38, v38
    v_exp_f32 v39, v39
    v_exp_f32 v40, v40
    v_exp_f32 v41, v41
    v_exp_f32 v42, v42
    v_mfma_f32_32x32x4_2b_bf16 v[70:101], v[186:187], v[36:37], 0 cbsz:1 abid:0
    v_exp_f32 v43, v43
    v_cmp_ne_u32 s[72:73], s51, v13
    v_exp_f32 v44, v44
    v_exp_f32 v45, v45
    s_and_b32 s54, s72, 0xff00
    s_cbranch_scc1 L_slow1
L_back1:
    buffer_load_dwordx4 v[194:197], v2, s[40:43], s58 offen
    v_exp_f32 v46, v46
    v_exp_f32 v47, v47
    v_exp_f32 v48, v48
    v_exp_f32 v49, v49
    buffer_load_dwordx2 v[192:193], v3, s[40:43], s58 offen offset:1024
    v_exp_f32 v50, v50
    s_waitcnt vmcnt(5)
    v_smfmac_f32_32x32x32_bf16 v[118:133], v[200:203], v[38:45], v104
    v_exp_f32 v51, v51
    v_exp_f32 v52, v52
    v_exp_f32 v53, v53
    v_exp_f32 v54, v54
    v_exp_f32 v55, v55
    v_smfmac_f32_32x32x32_bf16 v[118:133], v[204:207], v[46:53], v104
    v_exp_f32 v56, v56
    v_exp_f32 v57, v57
    v_exp_f32 v58, v58
    v_mfma_f32_32x32x16_bf16 v[70:85], v[182:185], v[26:29], v[70:85]
    v_exp_f32 v59, v59
    v_exp_f32 v60, v60
    v_exp_f32 v61, v61
    v_exp_f32 v62, v62
    v_exp_f32 v63, v63
    v_smfmac_f32_32x32x32_bf16 v[134:149], v[200:203], v[54:61], v104
    v_exp_f32 v64, v64
    v_exp_f32 v65, v65
    v_exp_f32 v66, v66
    v_exp_f32 v67, v67
    v_mfma_f32_32x32x16_bf16 v[86:101], v[182:185], v[30:33], v[86:101]
    v_exp_f32 v68, v68
    v_exp_f32 v69, v69
    v_exp_f32 v70, v70
    v_exp_f32 v71, v71
    v_smfmac_f32_32x32x32_bf16 v[134:149], v[204:207], v[62:69], v104
    v_exp_f32 v72, v72
    v_exp_f32 v73, v73
    v_exp_f32 v74, v74
    s_waitcnt vmcnt(4)
    v_mfma_f32_32x32x4_2b_bf16 v[38:69], v[186:187], v[34:35], 0 cbsz:1 abid:1
    v_exp_f32 v75, v75
    v_exp_f32 v76, v76
    v_exp_f32 v77, v77
    v_exp_f32 v78, v78
    v_exp_f32 v79, v79
    v_exp_f32 v80, v80
    v_exp_f32 v81, v81
    v_exp_f32 v82, v82
    v_smfmac_f32_32x32x32_bf16 v[150:165], v[200:203], v[70:77], v104
    v_exp_f32 v83, v83
    v_exp_f32 v84, v84
    v_exp_f32 v85, v85
    v_exp_f32 v86, v86
    v_exp_f32 v87, v87
    v_smfmac_f32_32x32x32_bf16 v[150:165], v[204:207], v[78:85], v104
    v_exp_f32 v88, v88
    v_exp_f32 v89, v89
    v_exp_f32 v90, v90
    v_mfma_f32_32x32x16_bf16 v[38:53], v[188:191], v[18:21], v[38:53]
    v_exp_f32 v91, v91
    v_exp_f32 v92, v92
    v_exp_f32 v93, v93
    v_exp_f32 v94, v94
    v_exp_f32 v95, v95
    s_setprio 2
    buffer_load_dwordx4 v[216:219], v4, s[40:43], s58 offen offset:1536
    buffer_load_dwordx4 v[220:223], v4, s[40:43], s58 offen offset:2304
    s_add_u32 s58, s58, 4096
    s_or_b32 s54, s72, s73
    s_cbranch_scc0 L_ref0
    s_mov_b64 exec, s[72:73]
    buffer_load_dword v13, v5, s[40:43], 0 offen sc1
    s_mov_b64 exec, -1
L_ref0:
    buffer_load_dwordx4 v[182:185], v2, s[40:43], s58 offen
    s_cbranch_vccz L_lk58
    s_setprio 3
L_lk58:
    v_smfmac_f32_32x32x32_bf16 v[166:181], v[200:203], v[86:93], v104
    v_exp_f32 v96, v96
    v_exp_f32 v97, v97
    v_exp_f32 v98, v98
    v_exp_f32 v99, v99
    v_exp_f32 v100, v100
    v_mfma_f32_32x32x16_bf16 v[54:69], v[188:191], v[22:25], v[54:69]
    v_exp_f32 v101, v101
    v_exp_f32 v38, v38
    v_exp_f32 v39, v39
    s_setprio 3
    v_smfmac_f32_32x32x32_bf16 v[166:181], v[204:207], v[94:101], v104
    v_exp_f32 v40, v40
    v_exp_f32 v41, v41
    v_exp_f32 v42, v42
    v_mfma_f32_32x32x4_2b_bf16 v[70:101], v[186:187], v[36:37], 0 cbsz:1 abid:1
    v_exp_f32 v43, v43
    v_exp_f32 v44, v44
    v_exp_f32 v45, v45
    v_exp_f32 v46, v46
    v_exp_f32 v47, v47
    v_exp_f32 v48, v48
    v_exp_f32 v49, v49
    v_exp_f32 v50, v50
    s_waitcnt vmcnt(5)
    v_smfmac_f32_32x32x32_bf16 v[118:133], v[208:211], v[38:45], v104
    v_exp_f32 v51, v51
    v_exp_f32 v52, v52
    v_exp_f32 v53, v53
    v_exp_f32 v54, v54
    v_exp_f32 v55, v55
    v_smfmac_f32_32x32x32_bf16 v[118:133], v[212:215], v[46:53], v104
    v_exp_f32 v56, v56
    v_exp_f32 v57, v57
    v_exp_f32 v58, v58
    v_mfma_f32_32x32x16_bf16 v[70:85], v[188:191], v[26:29], v[70:85]
    v_exp_f32 v59, v59
    v_exp_f32 v60, v60
    v_exp_f32 v61, v61
    v_exp_f32 v62, v62
    v_exp_f32 v63, v63
    v_smfmac_f32_32x32x32_bf16 v[134:149], v[208:211], v[54:61], v104
    v_exp_f32 v64, v64
    v_exp_f32 v65, v65
    v_exp_f32 v66, v66
    v_exp_f32 v67, v67
    v_mfma_f32_32x32x16_bf16 v[86:101], v[188:191], v[30:33], v[86:101]
    v_exp_f32 v68, v68
    v_exp_f32 v69, v69
    v_exp_f32 v70, v70
    v_exp_f32 v71, v71
    v_smfmac_f32_32x32x32_bf16 v[134:149], v[212:215], v[62:69], v104
    v_exp_f32 v72, v72
    v_exp_f32 v73, v73
    v_exp_f32 v74, v74
    s_waitcnt vmcnt(3)
    v_mfma_f32_32x32x4_2b_bf16 v[38:69], v[192:193], v[34:35], 0 cbsz:1 abid:0
    v_exp_f32 v75, v75
    v_exp_f32 v76, v76
    v_exp_f32 v77, v77
    v_exp_f32 v78, v78
    v_exp_f32 v79, v79
    v_exp_f32 v80, v80
    v_exp_f32 v81, v81
    v_exp_f32 v82, v82
    v_smfmac_f32_32x32x32_bf16 v[150:165], v[208:211], v[70:77], v104
    v_exp_f32 v83, v83
    v_exp_f32 v84, v84
    v_exp_f32 v85, v85
    v_exp_f32 v86, v86
    v_exp_f32 v87, v87
    v_smfmac_f32_32x32x32_bf16 v[150:165], v[212:215], v[78:85], v104
    v_exp_f32 v88, v88
    v_exp_f32 v89, v89
    v_exp_f32 v90, v90
    v_mfma_f32_32x32x16_bf16 v[38:53], v[194:197], v[18:21], v[38:53]
    v_exp_f32 v91, v91
    v_exp_f32 v92, v92
    v_exp_f32 v93, v93
    v_cmp_ne_u32 s[72:73], s51, v13
    v_exp_f32 v94, v94
    v_exp_f32 v95, v95
    s_setprio 2
    buffer_load_dwordx4 v[200:203], v4, s[40:43], s58 offen offset:1536
    buffer_load_dwordx4 v[204:207], v4, s[40:43], s58 offen offset:2304
    s_add_u32 s58, s58, 28672
    s_and_b32 s58, s58, 0x3ffff
    s_or_b32 s54, s72, s73
    s_cbranch_scc0 L_ref1
    s_mov_b64 exec, s[72:73]
    buffer_load_dword v13, v5, s[40:43], 0 offen sc1
    s_mov_b64 exec, -1
L_ref1:
    s_and_b32 s54, s72, 0xff0000
    s_cbranch_scc1 L_slow2
L_back2:
    buffer_load_dwordx4 v[188:191], v2, s[40:43], s58 offen
    buffer_load_dwordx2 v[198:199], v3, s[40:43], s58 offen offset:1024
    s_mul_i32 s55, s48, 81920
    s_lshr_b32 s54, s81, 1
    s_mul_i32 s54, s54, 10240
    s_add_u32 s55, s55, s54
    s_add_u32 s55, s55, 1048576
    s_lshl_b32 s54, s81, 1
    s_xor_b32 s54, s54, s47
    s_andn2_b32 s54, 3, s54
    s_mul_i32 s67, s54, 2560
    s_add_u32 s67, s67, s55
    s_xor_b32 s54, s54, 1
    s_mul_i32 s68, s54, 2560
    s_add_u32 s68, s68, s55
    s_waitcnt vmcnt(4)
    s_cbranch_vccz L_lk122
    s_setprio 3
L_lk122:
    v_smfmac_f32_32x32x32_bf16 v[166:181], v[208:211], v[86:93], v104
    v_exp_f32 v96, v96
    v_exp_f32 v97, v97
    v_exp_f32 v98, v98
    v_exp_f32 v99, v99
    v_exp_f32 v100, v100
    v_mfma_f32_32x32x16_bf16 v[54:69], v[194:197], v[22:25], v[54:69]
    v_exp_f32 v101, v101
    v_exp_f32 v38, v38
    v_exp_f32 v39, v39
    s_setprio 3
    v_smfmac_f32_32x32x32_bf16 v[166:181], v[212:215], v[94:101], v104
    v_exp_f32 v40, v40
    v_exp_f32 v41, v41
    v_exp_f32 v42, v42
    v_mfma_f32_32x32x4_2b_bf16 v[70:101], v[192:193], v[36:37], 0 cbsz:1 abid:0
    v_exp_f32 v43, v43
    v_exp_f32 v44, v44
    v_exp_f32 v45, v45
    v_exp_f32 v46, v46
    v_exp_f32 v47, v47
    v_exp_f32 v48, v48
    v_exp_f32 v49, v49
    v_exp_f32 v50, v50
    v_smfmac_f32_32x32x32_bf16 v[118:133], v[216:219], v[38:45], v104
    v_exp_f32 v51, v51
    v_exp_f32 v52, v52
    v_exp_f32 v53, v53
    v_exp_f32 v54, v54
    v_exp_f32 v55, v55
    v_smfmac_f32_32x32x32_bf16 v[118:133], v[220:223], v[46:53], v104
    v_exp_f32 v56, v56
    v_exp_f32 v57, v57
    v_exp_f32 v58, v58
    v_mfma_f32_32x32x16_bf16 v[70:85], v[194:197], v[26:29], v[70:85]
    v_exp_f32 v59, v59
    v_exp_f32 v60, v60
    v_exp_f32 v61, v61
    v_exp_f32 v62, v62
    v_exp_f32 v63, v63
    v_smfmac_f32_32x32x32_bf16 v[134:149], v[216:219], v[54:61], v104
    v_exp_f32 v64, v64
    v_exp_f32 v65, v65
    v_exp_f32 v66, v66
    v_exp_f32 v67, v67
    v_mfma_f32_32x32x16_bf16 v[86:101], v[194:197], v[30:33], v[86:101]
    v_exp_f32 v68, v68
    v_exp_f32 v69, v69
    v_exp_f32 v70, v70
    v_exp_f32 v71, v71
    v_smfmac_f32_32x32x32_bf16 v[134:149], v[220:223], v[62:69], v104
    v_exp_f32 v72, v72
    v_exp_f32 v73, v73
    v_exp_f32 v74, v74
    v_mfma_f32_32x32x4_2b_bf16 v[38:69], v[192:193], v[34:35], 0 cbsz:1 abid:1
    v_exp_f32 v75, v75
    v_exp_f32 v76, v76
    v_exp_f32 v77, v77
    v_exp_f32 v78, v78
    v_exp_f32 v79, v79
    v_exp_f32 v80, v80
    v_exp_f32 v81, v81
    v_exp_f32 v82, v82
    v_smfmac_f32_32x32x32_bf16 v[150:165], v[216:219], v[70:77], v104
    v_exp_f32 v83, v83
    v_exp_f32 v84, v84
    v_exp_f32 v85, v85
    v_exp_f32 v86, v86
    v_exp_f32 v87, v87
    v_smfmac_f32_32x32x32_bf16 v[150:165], v[220:223], v[78:85], v104
    v_exp_f32 v88, v88
    v_exp_f32 v89, v89
    v_exp_f32 v90, v90
    v_mfma_f32_32x32x16_bf16 v[38:53], v[182:185], v[18:21], v[38:53]
    v_exp_f32 v91, v91
    v_exp_f32 v92, v92
    v_exp_f32 v93, v93
    v_exp_f32 v94, v94
    v_exp_f32 v95, v95
    s_setprio 2
    buffer_load_dwordx4 v[208:211], v4, s[40:43], s58 offen offset:1536
    buffer_load_dwordx4 v[212:215], v4, s[40:43], s58 offen offset:2304
    s_add_u32 s58, s58, 4096
    buffer_load_dwordx4 v[194:197], v2, s[40:43], s58 offen
    s_add_u32 m0, s63, 0
    s_add_u32 s56, s86, 0
    s_mov_b32 exec_hi, 0xff
    buffer_load_dwordx4 v6, s[32:35], s56 offen lds
    s_add_u32 m0, s63, 5120
    s_add_u32 s56, s86, 51200
    buffer_load_dwordx4 v6, s[32:35], s56 offen lds
    s_mov_b32 exec_hi, -1
    s_waitcnt vmcnt(5)
    s_cbranch_vccz L_lk186
    s_setprio 3
L_lk186:
    v_smfmac_f32_32x32x32_bf16 v[166:181], v[216:219], v[86:93], v104
    v_exp_f32 v96, v96
    v_exp_f32 v97, v97
    v_exp_f32 v98, v98
    v_exp_f32 v99, v99
    v_exp_f32 v100, v100
    v_mfma_f32_32x32x16_bf16 v[54:69], v[182:185], v[22:25], v[54:69]
    v_exp_f32 v101, v101
    v_exp_f32 v38, v38
    v_exp_f32 v39, v39
    s_setprio 3
    v_smfmac_f32_32x32x32_bf16 v[166:181], v[220:223], v[94:101], v104
    v_exp_f32 v40, v40
    v_exp_f32 v41, v41
    v_exp_f32 v42, v42
    v_mfma_f32_32x32x4_2b_bf16 v[70:101], v[192:193], v[36:37], 0 cbsz:1 abid:1
    v_exp_f32 v43, v43
    v_exp_f32 v44, v44
    v_exp_f32 v45, v45
    v_exp_f32 v46, v46
    v_exp_f32 v47, v47
    v_exp_f32 v48, v48
    v_exp_f32 v49, v49
    v_exp_f32 v50, v50
    v_smfmac_f32_32x32x32_bf16 v[118:133], v[200:203], v[38:45], v104
    v_exp_f32 v51, v51
    v_exp_f32 v52, v52
    v_exp_f32 v53, v53
    v_exp_f32 v54, v54
    v_exp_f32 v55, v55
    v_smfmac_f32_32x32x32_bf16 v[118:133], v[204:207], v[46:53], v104
    v_exp_f32 v56, v56
    v_exp_f32 v57, v57
    v_exp_f32 v58, v58
    v_mfma_f32_32x32x16_bf16 v[70:85], v[182:185], v[26:29], v[70:85]
    v_exp_f32 v59, v59
    v_exp_f32 v60, v60
    v_exp_f32 v61, v61
    v_exp_f32 v62, v62
    v_exp_f32 v63, v63
    v_smfmac_f32_32x32x32_bf16 v[134:149], v[200:203], v[54:61], v104
    v_exp_f32 v64, v64
    v_exp_f32 v65, v65
    v_exp_f32 v66, v66
    v_exp_f32 v67, v67
    v_mfma_f32_32x32x16_bf16 v[86:101], v[182:185], v[30:33], v[86:101]
    v_exp_f32 v68, v68
    v_exp_f32 v69, v69
    v_exp_f32 v70, v70
    v_exp_f32 v71, v71
    v_smfmac_f32_32x32x32_bf16 v[134:149], v[204:207], v[62:69], v104
    v_exp_f32 v72, v72
    v_exp_f32 v73, v73
    v_exp_f32 v74, v74
    v_mfma_f32_32x32x4_2b_bf16 v[38:69], v[198:199], v[34:35], 0 cbsz:1 abid:0
    v_exp_f32 v75, v75
    v_exp_f32 v76, v76
    v_exp_f32 v77, v77
    v_exp_f32 v78, v78
    v_exp_f32 v79, v79
    v_exp_f32 v80, v80
    v_exp_f32 v81, v81
    v_exp_f32 v82, v82
    v_smfmac_f32_32x32x32_bf16 v[150:165], v[200:203], v[70:77], v104
    v_exp_f32 v83, v83
    v_exp_f32 v84, v84
    v_exp_f32 v85, v85
    v_exp_f32 v86, v86
    v_exp_f32 v87, v87
    v_smfmac_f32_32x32x32_bf16 v[150:165], v[204:207], v[78:85], v104
    v_exp_f32 v88, v88
    v_exp_f32 v89, v89
    v_exp_f32 v90, v90
    v_mfma_f32_32x32x16_bf16 v[38:53], v[188:191], v[18:21], v[38:53]
    v_exp_f32 v91, v91
    v_exp_f32 v92, v92
    v_exp_f32 v93, v93
    v_cmp_ne_u32 s[72:73], s51, v13
    v_exp_f32 v94, v94
    v_exp_f32 v95, v95
    s_setprio 2
    buffer_load_dwordx4 v[216:219], v4, s[40:43], s58 offen offset:1536
    buffer_load_dwordx4 v[220:223], v4, s[40:43], s58 offen offset:2304
    s_add_u32 s58, s58, 28672
    s_and_b32 s58, s58, 0x3ffff
    s_and_b32 s54, s72, 0xff000000
    s_cbranch_scc1 L_slow3
L_back3:
    buffer_load_dwordx4 v[182:185], v2, s[40:43], s58 offen
    buffer_load_dwordx2 v[186:187], v3, s[40:43], s58 offen offset:1024
    s_add_u32 m0, s63, 10240
    s_add_u32 s56, s87, 0
    s_mov_b32 exec_hi, 0xff
    buffer_load_dwordx4 v6, s[32:35], s56 offen lds
    s_add_u32 m0, s63, 15360
    s_add_u32 s56, s87, 51200
    buffer_load_dwordx4 v6, s[32:35], s56 offen lds
    s_mov_b32 exec_hi, -1
    s_cmp_eq_u32 s81, 0
    s_cbranch_scc0 L_blk0
    buffer_store_dwordx4 v[224:227], v2, s[40:43], s60 offen sc1
    s_mul_i32 s54, s46, 252
    s_add_u32 s54, s54, s61
    s_mov_b64 exec, 0xffff
    buffer_store_dwordx4 v[224:227], v2, s[40:43], s54 offen sc1
    s_mov_b64 exec, -1
L_blk0:
    s_waitcnt vmcnt(8)
    s_cbranch_vccz L_lk250
    s_setprio 3
L_lk250:
    v_smfmac_f32_32x32x32_bf16 v[166:181], v[200:203], v[86:93], v104
    v_exp_f32 v96, v96
    v_exp_f32 v97, v97
    v_exp_f32 v98, v98
    v_exp_f32 v99, v99
    v_exp_f32 v100, v100
    v_mfma_f32_32x32x16_bf16 v[54:69], v[188:191], v[22:25], v[54:69]
    v_exp_f32 v101, v101
    v_exp_f32 v38, v38
    v_exp_f32 v39, v39
    s_setprio 3
    v_smfmac_f32_32x32x32_bf16 v[166:181], v[204:207], v[94:101], v104
    v_exp_f32 v40, v40
    v_exp_f32 v41, v41
    v_exp_f32 v42, v42
    v_mfma_f32_32x32x4_2b_bf16 v[70:101], v[198:199], v[36:37], 0 cbsz:1 abid:0
    v_exp_f32 v43, v43
    v_exp_f32 v44, v44
    v_exp_f32 v45, v45
    v_exp_f32 v46, v46
    v_exp_f32 v47, v47
    v_exp_f32 v48, v48
    v_exp_f32 v49, v49
    v_exp_f32 v50, v50
    v_smfmac_f32_32x32x32_bf16 v[118:133], v[208:211], v[38:45], v104
    v_exp_f32 v51, v51
    v_exp_f32 v52, v52
    v_exp_f32 v53, v53
    v_exp_f32 v54, v54
    v_exp_f32 v55, v55
    v_smfmac_f32_32x32x32_bf16 v[118:133], v[212:215], v[46:53], v104
    v_exp_f32 v56, v56
    v_exp_f32 v57, v57
    v_exp_f32 v58, v58
    v_mfma_f32_32x32x16_bf16 v[70:85], v[188:191], v[26:29], v[70:85]
    v_exp_f32 v59, v59
    v_exp_f32 v60, v60
    v_exp_f32 v61, v61
    v_exp_f32 v62, v62
    v_exp_f32 v63, v63
    v_smfmac_f32_32x32x32_bf16 v[134:149], v[208:211], v[54:61], v104
    v_exp_f32 v64, v64
    v_exp_f32 v65, v65
    v_exp_f32 v66, v66
    v_exp_f32 v67, v67
    v_mfma_f32_32x32x16_bf16 v[86:101], v[188:191], v[30:33], v[86:101]
    v_exp_f32 v68, v68
    v_exp_f32 v69, v69
    v_exp_f32 v70, v70
    v_exp_f32 v71, v71
    v_smfmac_f32_32x32x32_bf16 v[134:149], v[212:215], v[62:69], v104
    v_exp_f32 v72, v72
    v_exp_f32 v73, v73
    v_exp_f32 v74, v74
    v_mfma_f32_32x32x4_2b_bf16 v[38:69], v[198:199], v[34:35], 0 cbsz:1 abid:1
    v_exp_f32 v75, v75
    v_exp_f32 v76, v76
    v_exp_f32 v77, v77
    v_exp_f32 v78, v78
    v_exp_f32 v79, v79
    v_exp_f32 v80, v80
    v_exp_f32 v81, v81
    v_exp_f32 v82, v82
    v_smfmac_f32_32x32x32_bf16 v[150:165], v[208:211], v[70:77], v104
    v_exp_f32 v83, v83
    v_exp_f32 v84, v84
    v_exp_f32 v85, v85
    v_exp_f32 v86, v86
    v_exp_f32 v87, v87
    v_smfmac_f32_32x32x32_bf16 v[150:165], v[212:215], v[78:85], v104
    v_exp_f32 v88, v88
    v_exp_f32 v89, v89
    v_exp_f32 v90, v90
    v_mfma_f32_32x32x16_bf16 v[38:53], v[194:197], v[18:21], v[38:53]
    v_exp_f32 v91, v91
    v_exp_f32 v92, v92
    v_exp_f32 v93, v93
    v_exp_f32 v94, v94
    v_exp_f32 v95, v95
    s_setprio 2
    buffer_load_dwordx4 v[200:203], v4, s[40:43], s58 offen offset:1536
    buffer_load_dwordx4 v[204:207], v4, s[40:43], s58 offen offset:2304
    s_add_u32 s58, s58, 4096
    buffer_load_dwordx4 v[188:191], v2, s[40:43], s58 offen
    s_add_u32 m0, s63, 20480
    s_min_u32 s56, s86, s87
    s_add_u32 s56, s56, 0
    s_mov_b32 exec_hi, 0xff
    buffer_load_dwordx4 v7, s[32:35], s56 offen lds
    s_add_u32 m0, s63, 25600
    s_add_u32 s56, s88, 0
    buffer_load_dwordx4 v6, s[32:35], s56 offen lds
    s_mov_b32 exec_hi, -1
    s_cmp_eq_u32 s81, 1
    s_cbranch_scc0 L_blk1
    buffer_store_dwordx4 v[224:227], v2, s[40:43], s60 offen sc1
    s_mul_i32 s54, s46, 252
    s_add_u32 s54, s54, s61
    s_mov_b64 exec, 0xffff
    buffer_store_dwordx4 v[224:227], v2, s[40:43], s54 offen sc1
    s_mov_b64 exec, -1
L_blk1:
    s_waitcnt vmcnt(7)
    s_cbranch_vccz L_lk314
    s_setprio 3
L_lk314:
    v_smfmac_f32_32x32x32_bf16 v[166:181], v[208:211], v[86:93], v104
    v_exp_f32 v96, v96
    v_exp_f32 v97, v97
    v_exp_f32 v98, v98
    v_exp_f32 v99, v99
    v_exp_f32 v100, v100
    v_mfma_f32_32x32x16_bf16 v[54:69], v[194:197], v[22:25], v[54:69]
    v_exp_f32 v101, v101
    v_exp_f32 v38, v38
    v_exp_f32 v39, v39
    s_setprio 3
    v_smfmac_f32_32x32x32_bf16 v[166:181], v[212:215], v[94:101], v104
    v_exp_f32 v40, v40
    v_exp_f32 v41, v41
    v_exp_f32 v42, v42
    v_mfma_f32_32x32x4_2b_bf16 v[70:101], v[198:199], v[36:37], 0 cbsz:1 abid:1
    v_exp_f32 v43, v43
    v_exp_f32 v44, v44
    v_exp_f32 v45, v45
    v_exp_f32 v46, v46
    v_exp_f32 v47, v47
    v_exp_f32 v48, v48
    v_exp_f32 v49, v49
    v_exp_f32 v50, v50
    v_smfmac_f32_32x32x32_bf16 v[118:133], v[216:219], v[38:45], v104
    v_exp_f32 v51, v51
    v_exp_f32 v52, v52
    v_exp_f32 v53, v53
    v_exp_f32 v54, v54
    v_exp_f32 v55, v55
    v_smfmac_f32_32x32x32_bf16 v[118:133], v[220:223], v[46:53], v104
    v_exp_f32 v56, v56
    v_exp_f32 v57, v57
    v_exp_f32 v58, v58
    v_mfma_f32_32x32x16_bf16 v[70:85], v[194:197], v[26:29], v[70:85]
    v_exp_f32 v59, v59
    v_exp_f32 v60, v60
    v_exp_f32 v61, v61
    v_exp_f32 v62, v62
    v_exp_f32 v63, v63
    v_smfmac_f32_32x32x32_bf16 v[134:149], v[216:219], v[54:61], v104
    v_exp_f32 v64, v64
    v_exp_f32 v65, v65
    v_exp_f32 v66, v66
    v_exp_f32 v67, v67
    v_mfma_f32_32x32x16_bf16 v[86:101], v[194:197], v[30:33], v[86:101]
    v_exp_f32 v68, v68
    v_exp_f32 v69, v69
    v_exp_f32 v70, v70
    v_exp_f32 v71, v71
    v_smfmac_f32_32x32x32_bf16 v[134:149], v[220:223], v[62:69], v104
    v_exp_f32 v72, v72
    v_exp_f32 v73, v73
    v_exp_f32 v74, v74
    v_mfma_f32_32x32x4_2b_bf16 v[38:69], v[186:187], v[34:35], 0 cbsz:1 abid:0
    v_exp_f32 v75, v75
    v_exp_f32 v76, v76
    v_exp_f32 v77, v77
    v_exp_f32 v78, v78
    v_exp_f32 v79, v79
    v_exp_f32 v80, v80
    v_exp_f32 v81, v81
    v_exp_f32 v82, v82
    v_smfmac_f32_32x32x32_bf16 v[150:165], v[216:219], v[70:77], v104
    v_exp_f32 v83, v83
    v_exp_f32 v84, v84
    v_exp_f32 v85, v85
    v_exp_f32 v86, v86
    v_exp_f32 v87, v87
    v_smfmac_f32_32x32x32_bf16 v[150:165], v[220:223], v[78:85], v104
    v_exp_f32 v88, v88
    v_exp_f32 v89, v89
    v_exp_f32 v90, v90
    v_mfma_f32_32x32x16_bf16 v[38:53], v[182:185], v[18:21], v[38:53]
    v_exp_f32 v91, v91
    v_exp_f32 v92, v92
    v_exp_f32 v93, v93
    v_exp_f32 v94, v94
    v_exp_f32 v95, v95
    s_setprio 2
    buffer_load_dwordx4 v[208:211], v4, s[40:43], s58 offen offset:1536
    buffer_load_dwordx4 v[212:215], v4, s[40:43], s58 offen offset:2304
    s_add_u32 s58, s58, 28672
    s_and_b32 s58, s58, 0x3ffff
    s_and_b32 s54, s73, 0xff
    s_cbranch_scc1 L_slow4
L_back4:
    buffer_load_dwordx4 v[194:197], v2, s[40:43], s58 offen
    buffer_load_dwordx2 v[192:193], v3, s[40:43], s58 offen offset:1024
    s_add_u32 m0, s63, 30720
    s_add_u32 s56, s88, 51200
    s_mov_b32 exec_hi, 0xff
    buffer_load_dwordx4 v6, s[32:35], s56 offen lds
    s_add_u32 m0, s63, 35840
    s_add_u32 s56, s89, 0
    buffer_load_dwordx4 v6, s[32:35], s56 offen lds
    s_mov_b32 exec_hi, -1
    s_cmp_eq_u32 s81, 2
    s_cbranch_scc0 L_blk2
    buffer_store_dwordx4 v[224:227], v2, s[40:43], s60 offen sc1
    s_mul_i32 s54, s46, 252
    s_add_u32 s54, s54, s61
    s_mov_b64 exec, 0xffff
    buffer_store_dwordx4 v[224:227], v2, s[40:43], s54 offen sc1
    s_mov_b64 exec, -1
L_blk2:
    s_waitcnt vmcnt(8)
    s_cbranch_vccz L_lk378
    s_setprio 3
L_lk378:
    v_smfmac_f32_32x32x32_bf16 v[166:181], v[216:219], v[86:93], v104
    v_exp_f32 v96, v96
    v_exp_f32 v97, v97
    v_exp_f32 v98, v98
    v_exp_f32 v99, v99
    v_exp_f32 v100, v100
    v_mfma_f32_32x32x16_bf16 v[54:69], v[182:185], v[22:25], v[54:69]
    v_exp_f32 v101, v101
    v_exp_f32 v38, v38
    v_exp_f32 v39, v39
    s_setprio 3
    v_smfmac_f32_32x32x32_bf16 v[166:181], v[220:223], v[94:101], v104
    v_exp_f32 v40, v40
    v_exp_f32 v41, v41
    v_exp_f32 v42, v42
    v_mfma_f32_32x32x4_2b_bf16 v[70:101], v[186:187], v[36:37], 0 cbsz:1 abid:0
    v_exp_f32 v43, v43
    v_exp_f32 v44, v44
    v_exp_f32 v45, v45
    v_exp_f32 v46, v46
    v_exp_f32 v47, v47
    v_exp_f32 v48, v48
    v_exp_f32 v49, v49
    v_exp_f32 v50, v50
    v_smfmac_f32_32x32x32_bf16 v[118:133], v[200:203], v[38:45], v104
    v_exp_f32 v51, v51
    v_exp_f32 v52, v52
    v_exp_f32 v53, v53
    v_exp_f32 v54, v54
    v_exp_f32 v55, v55
    v_smfmac_f32_32x32x32_bf16 v[118:133], v[204:207], v[46:53], v104
    v_exp_f32 v56, v56
    v_exp_f32 v57, v57
    v_exp_f32 v58, v58
    v_mfma_f32_32x32x16_bf16 v[70:85], v[182:185], v[26:29], v[70:85]
    v_exp_f32 v59, v59
    v_exp_f32 v60, v60
    v_exp_f32 v61, v61
    v_exp_f32 v62, v62
    v_exp_f32 v63, v63
    v_smfmac_f32_32x32x32_bf16 v[134:149], v[200:203], v[54:61], v104
    v_exp_f32 v64, v64
    v_exp_f32 v65, v65
    v_exp_f32 v66, v66
    v_exp_f32 v67, v67
    v_mfma_f32_32x32x16_bf16 v[86:101], v[182:185], v[30:33], v[86:101]
    v_exp_f32 v68, v68
    v_exp_f32 v69, v69
    v_exp_f32 v70, v70
    v_exp_f32 v71, v71
    v_smfmac_f32_32x32x32_bf16 v[134:149], v[204:207], v[62:69], v104
    v_exp_f32 v72, v72
    v_exp_f32 v73, v73
    v_exp_f32 v74, v74
    v_mfma_f32_32x32x4_2b_bf16 v[38:69], v[186:187], v[34:35], 0 cbsz:1 abid:1
    v_exp_f32 v75, v75
    v_exp_f32 v76, v76
    v_exp_f32 v77, v77
    v_exp_f32 v78, v78
    v_exp_f32 v79, v79
    v_exp_f32 v80, v80
    v_exp_f32 v81, v81
    v_exp_f32 v82, v82
    v_smfmac_f32_32x32x32_bf16 v[150:165], v[200:203], v[70:77], v104
    v_exp_f32 v83, v83
    v_exp_f32 v84, v84
    v_exp_f32 v85, v85
    v_exp_f32 v86, v86
    v_exp_f32 v87, v87
    v_smfmac_f32_32x32x32_bf16 v[150:165], v[204:207], v[78:85], v104
    v_exp_f32 v88, v88
    v_exp_f32 v89, v89
    v_exp_f32 v90, v90
    v_mfma_f32_32x32x16_bf16 v[38:53], v[188:191], v[18:21], v[38:53]
    v_exp_f32 v91, v91
    v_exp_f32 v92, v92
    v_exp_f32 v93, v93
    v_exp_f32 v94, v94
    v_exp_f32 v95, v95
    s_setprio 2
    buffer_load_dwordx4 v[216:219], v4, s[40:43], s58 offen offset:1536
    buffer_load_dwordx4 v[220:223], v4, s[40:43], s58 offen offset:2304
    s_add_u32 s58, s58, 4096
    buffer_load_dwordx4 v[182:185], v2, s[40:43], s58 offen
    s_add_u32 m0, s63, 40960
    s_add_u32 s56, s89, 51200
    s_mov_b32 exec_hi, 0xff
    buffer_load_dwordx4 v6, s[32:35], s56 offen lds
    s_add_u32 m0, s63, 46080
    s_min_u32 s56, s88, s89
    s_add_u32 s56, s56, 0
    buffer_load_dwordx4 v7, s[32:35], s56 offen lds
    s_mov_b32 exec_hi, -1
    s_cmp_eq_u32 s81, 3
    s_cbranch_scc0 L_blk3
    buffer_store_dwordx4 v[224:227], v2, s[40:43], s60 offen sc1
    s_mul_i32 s54, s46, 252
    s_add_u32 s54, s54, s61
    s_mov_b64 exec, 0xffff
    buffer_store_dwordx4 v[224:227], v2, s[40:43], s54 offen sc1
    s_mov_b64 exec, -1
L_blk3:
    s_waitcnt vmcnt(7)
    s_cbranch_vccz L_lk442
    s_setprio 3
L_lk442:
    v_smfmac_f32_32x32x32_bf16 v[166:181], v[200:203], v[86:93], v104
    v_exp_f32 v96, v96
    v_exp_f32 v97, v97
    v_exp_f32 v98, v98
    v_exp_f32 v99, v99
    v_exp_f32 v100, v100
    v_mfma_f32_32x32x16_bf16 v[54:69], v[188:191], v[22:25], v[54:69]
    v_exp_f32 v101, v101
    v_exp_f32 v38, v38
    v_exp_f32 v39, v39
    s_setprio 3
    v_smfmac_f32_32x32x32_bf16 v[166:181], v[204:207], v[94:101], v104
    v_exp_f32 v40, v40
    v_exp_f32 v41, v41
    v_exp_f32 v42, v42
    v_mfma_f32_32x32x4_2b_bf16 v[70:101], v[186:187], v[36:37], 0 cbsz:1 abid:1
    v_exp_f32 v43, v43
    v_exp_f32 v44, v44
    v_exp_f32 v45, v45
    v_exp_f32 v46, v46
    v_exp_f32 v47, v47
    v_exp_f32 v48, v48
    v_exp_f32 v49, v49
    v_exp_f32 v50, v50
    v_smfmac_f32_32x32x32_bf16 v[118:133], v[208:211], v[38:45], v104
    v_exp_f32 v51, v51
    v_exp_f32 v52, v52
    v_exp_f32 v53, v53
    v_exp_f32 v54, v54
    v_exp_f32 v55, v55
    v_smfmac_f32_32x32x32_bf16 v[118:133], v[212:215], v[46:53], v104
    v_exp_f32 v56, v56
    v_exp_f32 v57, v57
    v_exp_f32 v58, v58
    v_mfma_f32_32x32x16_bf16 v[70:85], v[188:191], v[26:29], v[70:85]
    v_exp_f32 v59, v59
    v_exp_f32 v60, v60
    v_exp_f32 v61, v61
    v_exp_f32 v62, v62
    v_exp_f32 v63, v63
    v_smfmac_f32_32x32x32_bf16 v[134:149], v[208:211], v[54:61], v104
    v_exp_f32 v64, v64
    v_exp_f32 v65, v65
    v_exp_f32 v66, v66
    v_exp_f32 v67, v67
    v_mfma_f32_32x32x16_bf16 v[86:101], v[188:191], v[30:33], v[86:101]
    v_exp_f32 v68, v68
    v_exp_f32 v69, v69
    v_exp_f32 v70, v70
    v_exp_f32 v71, v71
    v_smfmac_f32_32x32x32_bf16 v[134:149], v[212:215], v[62:69], v104
    v_exp_f32 v72, v72
    v_exp_f32 v73, v73
    v_exp_f32 v74, v74
    v_mfma_f32_32x32x4_2b_bf16 v[38:69], v[192:193], v[34:35], 0 cbsz:1 abid:0
    v_exp_f32 v75, v75
    v_exp_f32 v76, v76
    v_exp_f32 v77, v77
    v_exp_f32 v78, v78
    v_exp_f32 v79, v79
    v_exp_f32 v80, v80
    v_exp_f32 v81, v81
    v_exp_f32 v82, v82
    v_smfmac_f32_32x32x32_bf16 v[150:165], v[208:211], v[70:77], v104
    v_exp_f32 v83, v83
    v_exp_f32 v84, v84
    v_exp_f32 v85, v85
    v_exp_f32 v86, v86
    v_exp_f32 v87, v87
    v_smfmac_f32_32x32x32_bf16 v[150:165], v[212:215], v[78:85], v104
    v_exp_f32 v88, v88
    v_exp_f32 v89, v89
    v_exp_f32 v90, v90
    v_mfma_f32_32x32x16_bf16 v[38:53], v[194:197], v[18:21], v[38:53]
    v_exp_f32 v91, v91
    v_exp_f32 v92, v92
    v_exp_f32 v93, v93
    v_exp_f32 v94, v94
    v_exp_f32 v95, v95
    s_setprio 2
    buffer_load_dwordx4 v[200:203], v4, s[40:43], s58 offen offset:1536
    buffer_load_dwordx4 v[204:207], v4, s[40:43], s58 offen offset:2304
    s_add_u32 s58, s58, 28672
    s_and_b32 s58, s58, 0x3ffff
    s_and_b32 s54, s73, 0xff00
    s_cbranch_scc1 L_slow5
L_back5:
    buffer_load_dwordx4 v[188:191], v2, s[40:43], s58 offen
    buffer_load_dwordx2 v[198:199], v3, s[40:43], s58 offen offset:1024
    s_add_u32 m0, s63, 51200
    s_add_u32 s56, s86, 409600
    s_mov_b32 exec_hi, 0xff
    buffer_load_dwordx4 v6, s[32:35], s56 offen lds
    s_add_u32 m0, s63, 56320
    s_add_u32 s56, s86, 460800
    buffer_load_dwordx4 v6, s[32:35], s56 offen lds
    s_mov_b32 exec_hi, -1
    s_cmp_eq_u32 s81, 0
    s_cbranch_scc0 L_blk4
    buffer_load_dwordx4 v[232:235], v2, s[40:43], s60 offen sc1
    buffer_load_dword v236, v16, s[40:43], s61 offen sc1
L_blk4:
    s_waitcnt vmcnt(8)
    s_cbranch_vccz L_lk506
    s_setprio 3
L_lk506:
    v_smfmac_f32_32x32x32_bf16 v[166:181], v[208:211], v[86:93], v104
    v_exp_f32 v96, v96
    v_exp_f32 v97, v97
    v_exp_f32 v98, v98
    v_exp_f32 v99, v99
    v_exp_f32 v100, v100
    v_mfma_f32_32x32x16_bf16 v[54:69], v[194:197], v[22:25], v[54:69]
    v_exp_f32 v101, v101
    v_exp_f32 v38, v38
    v_exp_f32 v39, v39
    s_setprio 3
    v_smfmac_f32_32x32x32_bf16 v[166:181], v[212:215], v[94:101], v104
    v_exp_f32 v40, v40
    v_exp_f32 v41, v41
    v_exp_f32 v42, v42
    v_mfma_f32_32x32x4_2b_bf16 v[70:101], v[192:193], v[36:37], 0 cbsz:1 abid:0
    v_exp_f32 v43, v43
    v_exp_f32 v44, v44
    v_exp_f32 v45, v45
    v_exp_f32 v46, v46
    v_exp_f32 v47, v47
    v_exp_f32 v48, v48
    v_exp_f32 v49, v49
    v_exp_f32 v50, v50
    v_smfmac_f32_32x32x32_bf16 v[118:133], v[216:219], v[38:45], v104
    v_exp_f32 v51, v51
    v_exp_f32 v52, v52
    v_exp_f32 v53, v53
    v_exp_f32 v54, v54
    v_exp_f32 v55, v55
    v_smfmac_f32_32x32x32_bf16 v[118:133], v[220:223], v[46:53], v104
    v_exp_f32 v56, v56
    v_exp_f32 v57, v57
    v_exp_f32 v58, v58
    v_mfma_f32_32x32x16_bf16 v[70:85], v[194:197], v[26:29], v[70:85]
    v_exp_f32 v59, v59
    v_exp_f32 v60, v60
    v_exp_f32 v61, v61
    v_exp_f32 v62, v62
    v_exp_f32 v63, v63
    v_smfmac_f32_32x32x32_bf16 v[134:149], v[216:219], v[54:61], v104
    v_exp_f32 v64, v64
    v_exp_f32 v65, v65
    v_exp_f32 v66, v66
    v_exp_f32 v67, v67
    v_mfma_f32_32x32x16_bf16 v[86:101], v[194:197], v[30:33], v[86:101]
    v_exp_f32 v68, v68
    v_exp_f32 v69, v69
    v_exp_f32 v70, v70
    v_exp_f32 v71, v71
    v_smfmac_f32_32x32x32_bf16 v[134:149], v[220:223], v[62:69], v104
    v_exp_f32 v72, v72
    v_exp_f32 v73, v73
    v_exp_f32 v74, v74
    v_mfma_f32_32x32x4_2b_bf16 v[38:69], v[192:193], v[34:35], 0 cbsz:1 abid:1
    v_exp_f32 v75, v75
    v_exp_f32 v76, v76
    v_exp_f32 v77, v77
    v_exp_f32 v78, v78
    v_exp_f32 v79, v79
    v_exp_f32 v80, v80
    v_exp_f32 v81, v81
    v_exp_f32 v82, v82
    v_smfmac_f32_32x32x32_bf16 v[150:165], v[216:219], v[70:77], v104
    v_exp_f32 v83, v83
    v_exp_f32 v84, v84
    v_exp_f32 v85, v85
    v_exp_f32 v86, v86
    v_exp_f32 v87, v87
    v_smfmac_f32_32x32x32_bf16 v[150:165], v[220:223], v[78:85], v104
    v_exp_f32 v88, v88
    v_exp_f32 v89, v89
    v_exp_f32 v90, v90
    v_mfma_f32_32x32x16_bf16 v[38:53], v[182:185], v[18:21], v[38:53]
    v_exp_f32 v91, v91
    v_exp_f32 v92, v92
    v_exp_f32 v93, v93
    v_exp_f32 v94, v94
    v_exp_f32 v95, v95
    s_setprio 2
    buffer_load_dwordx4 v[208:211], v4, s[40:43], s58 offen offset:1536
    buffer_load_dwordx4 v[212:215], v4, s[40:43], s58 offen offset:2304
    s_add_u32 s58, s58, 4096
    buffer_load_dwordx4 v[194:197], v2, s[40:43], s58 offen
    s_add_u32 m0, s63, 61440
    s_add_u32 s56, s87, 409600
    s_mov_b32 exec_hi, 0xff
    buffer_load_dwordx4 v6, s[32:35], s56 offen lds
    s_add_u32 m0, s63, 66560
    s_add_u32 s56, s87, 460800
    buffer_load_dwordx4 v6, s[32:35], s56 offen lds
    s_mov_b32 exec_hi, -1
    s_cmp_eq_u32 s81, 1
    s_cbranch_scc0 L_blk5
    buffer_load_dwordx4 v[232:235], v2, s[40:43], s60 offen sc1
    buffer_load_dword v236, v16, s[40:43], s61 offen sc1
L_blk5:
    s_waitcnt vmcnt(7)
    s_cbranch_vccz L_lk570
    s_setprio 3
L_lk570:
    v_smfmac_f32_32x32x32_bf16 v[166:181], v[216:219], v[86:93], v104
    v_exp_f32 v96, v96
    v_exp_f32 v97, v97
    v_exp_f32 v98, v98
    v_exp_f32 v99, v99
    v_exp_f32 v100, v100
    v_mfma_f32_32x32x16_bf16 v[54:69], v[182:185], v[22:25], v[54:69]
    v_exp_f32 v101, v101
    v_exp_f32 v38, v38
    v_exp_f32 v39, v39
    s_setprio 3
    v_smfmac_f32_32x32x32_bf16 v[166:181], v[220:223], v[94:101], v104
    v_exp_f32 v40, v40
    v_exp_f32 v41, v41
    v_exp_f32 v42, v42
    v_mfma_f32_32x32x4_2b_bf16 v[70:101], v[192:193], v[36:37], 0 cbsz:1 abid:1
    v_exp_f32 v43, v43
    v_exp_f32 v44, v44
    v_exp_f32 v45, v45
    v_exp_f32 v46, v46
    v_exp_f32 v47, v47
    v_exp_f32 v48, v48
    v_exp_f32 v49, v49
    v_exp_f32 v50, v50
    v_smfmac_f32_32x32x32_bf16 v[118:133], v[200:203], v[38:45], v104
    v_exp_f32 v51, v51
    v_exp_f32 v52, v52
    v_exp_f32 v53, v53
    v_exp_f32 v54, v54
    v_exp_f32 v55, v55
    v_smfmac_f32_32x32x32_bf16 v[118:133], v[204:207], v[46:53], v104
    v_exp_f32 v56, v56
    v_exp_f32 v57, v57
    v_exp_f32 v58, v58
    v_mfma_f32_32x32x16_bf16 v[70:85], v[182:185], v[26:29], v[70:85]
    v_exp_f32 v59, v59
    v_exp_f32 v60, v60
    v_exp_f32 v61, v61
    v_exp_f32 v62, v62
    v_exp_f32 v63, v63
    v_smfmac_f32_32x32x32_bf16 v[134:149], v[200:203], v[54:61], v104
    v_exp_f32 v64, v64
    v_exp_f32 v65, v65
    v_exp_f32 v66, v66
    v_exp_f32 v67, v67
    v_mfma_f32_32x32x16_bf16 v[86:101], v[182:185], v[30:33], v[86:101]
    v_exp_f32 v68, v68
    v_exp_f32 v69, v69
    v_exp_f32 v70, v70
    v_exp_f32 v71, v71
    v_smfmac_f32_32x32x32_bf16 v[134:149], v[204:207], v[62:69], v104
    v_exp_f32 v72, v72
    v_exp_f32 v73, v73
    v_exp_f32 v74, v74
    v_mfma_f32_32x32x4_2b_bf16 v[38:69], v[198:199], v[34:35], 0 cbsz:1 abid:0
    v_exp_f32 v75, v75
    v_exp_f32 v76, v76
    v_exp_f32 v77, v77
    v_exp_f32 v78, v78
    v_exp_f32 v79, v79
    v_exp_f32 v80, v80
    v_exp_f32 v81, v81
    v_exp_f32 v82, v82
    v_smfmac_f32_32x32x32_bf16 v[150:165], v[200:203], v[70:77], v104
    v_exp_f32 v83, v83
    v_exp_f32 v84, v84
    v_exp_f32 v85, v85
    v_exp_f32 v86, v86
    v_exp_f32 v87, v87
    v_smfmac_f32_32x32x32_bf16 v[150:165], v[204:207], v[78:85], v104
    v_exp_f32 v88, v88
    v_exp_f32 v89, v89
    v_exp_f32 v90, v90
    v_mfma_f32_32x32x16_bf16 v[38:53], v[188:191], v[18:21], v[38:53]
    v_exp_f32 v91, v91
    v_exp_f32 v92, v92
    v_exp_f32 v93, v93
    v_exp_f32 v94, v94
    v_exp_f32 v95, v95
    s_setprio 2
    buffer_load_dwordx4 v[216:219], v4, s[40:43], s58 offen offset:1536
    buffer_load_dwordx4 v[220:223], v4, s[40:43], s58 offen offset:2304
    s_add_u32 s58, s58, 28672
    s_and_b32 s58, s58, 0x3ffff
    s_and_b32 s54, s73, 0xff0000
    s_cbranch_scc1 L_slow6
L_back6:
    buffer_load_dwordx4 v[182:185], v2, s[40:43], s58 offen
    buffer_load_dwordx2 v[186:187], v3, s[40:43], s58 offen offset:1024
    s_add_u32 m0, s63, 71680
    s_min_u32 s56, s86, s87
    s_add_u32 s56, s56, 409600
    s_mov_b32 exec_hi, 0xff
    buffer_load_dwordx4 v7, s[32:35], s56 offen lds
    s_add_u32 m0, s63, 76800
    s_add_u32 s56, s88, 409600
    buffer_load_dwordx4 v6, s[32:35], s56 offen lds
    s_mov_b32 exec_hi, -1
    s_mov_b64 exec, 1
    buffer_store_dword v228, v2, s[40:43], s76 offen sc1
    s_mov_b64 exec, -1
    s_cmp_eq_u32 s81, 2
    s_cbranch_scc0 L_blk6
    buffer_load_dwordx4 v[232:235], v2, s[40:43], s60 offen sc1
    buffer_load_dword v236, v16, s[40:43], s61 offen sc1
L_blk6:
    s_waitcnt vmcnt(9)
    s_cbranch_vccz L_lk634
    s_setprio 3
L_lk634:
    v_smfmac_f32_32x32x32_bf16 v[166:181], v[200:203], v[86:93], v104
    v_exp_f32 v96, v96
    v_exp_f32 v97, v97
    v_exp_f32 v98, v98
    v_exp_f32 v99, v99
    v_exp_f32 v100, v100
    v_mfma_f32_32x32x16_bf16 v[54:69], v[188:191], v[22:25], v[54:69]
    v_exp_f32 v101, v101
    v_exp_f32 v38, v38
    v_exp_f32 v39, v39
    s_setprio 3
    v_smfmac_f32_32x32x32_bf16 v[166:181], v[204:207], v[94:101], v104
    v_exp_f32 v40, v40
    v_exp_f32 v41, v41
    v_exp_f32 v42, v42
    v_mfma_f32_32x32x4_2b_bf16 v[70:101], v[198:199], v[36:37], 0 cbsz:1 abid:0
    v_exp_f32 v43, v43
    v_exp_f32 v44, v44
    v_exp_f32 v45, v45
    v_exp_f32 v46, v46
    v_exp_f32 v47, v47
    v_exp_f32 v48, v48
    v_exp_f32 v49, v49
    v_exp_f32 v50, v50
    v_smfmac_f32_32x32x32_bf16 v[118:133], v[208:211], v[38:45], v104
    v_exp_f32 v51, v51
    v_exp_f32 v52, v52
    v_exp_f32 v53, v53
    v_exp_f32 v54, v54
    v_exp_f32 v55, v55
    v_smfmac_f32_32x32x32_bf16 v[118:133], v[212:215], v[46:53], v104
    v_exp_f32 v56, v56
    v_exp_f32 v57, v57
    v_exp_f32 v58, v58
    v_mfma_f32_32x32x16_bf16 v[70:85], v[188:191], v[26:29], v[70:85]
    v_exp_f32 v59, v59
    v_exp_f32 v60, v60
    v_exp_f32 v61, v61
    v_exp_f32 v62, v62
    v_exp_f32 v63, v63
    v_smfmac_f32_32x32x32_bf16 v[134:149], v[208:211], v[54:61], v104
    v_exp_f32 v64, v64
    v_exp_f32 v65, v65
    v_exp_f32 v66, v66
    v_exp_f32 v67, v67
    v_mfma_f32_32x32x16_bf16 v[86:101], v[188:191], v[30:33], v[86:101]
    v_exp_f32 v68, v68
    v_exp_f32 v69, v69
    v_exp_f32 v70, v70
    v_exp_f32 v71, v71
    v_smfmac_f32_32x32x32_bf16 v[134:149], v[212:215], v[62:69], v104
    v_exp_f32 v72, v72
    v_exp_f32 v73, v73
    v_exp_f32 v74, v74
    v_mfma_f32_32x32x4_2b_bf16 v[38:69], v[198:199], v[34:35], 0 cbsz:1 abid:1
    v_exp_f32 v75, v75
    v_exp_f32 v76, v76
    v_exp_f32 v77, v77
    v_exp_f32 v78, v78
    v_exp_f32 v79, v79
    v_exp_f32 v80, v80
    v_exp_f32 v81, v81
    v_exp_f32 v82, v82
    v_smfmac_f32_32x32x32_bf16 v[150:165], v[208:211], v[70:77], v104
    v_exp_f32 v83, v83
    v_exp_f32 v84, v84
    v_exp_f32 v85, v85
    v_exp_f32 v86, v86
    v_exp_f32 v87, v87
    v_smfmac_f32_32x32x32_bf16 v[150:165], v[212:215], v[78:85], v104
    v_exp_f32 v88, v88
    v_exp_f32 v89, v89
    v_exp_f32 v90, v90
    v_mfma_f32_32x32x16_bf16 v[38:53], v[194:197], v[18:21], v[38:53]
    v_exp_f32 v91, v91
    v_exp_f32 v92, v92
    v_exp_f32 v93, v93
    v_exp_f32 v94, v94
    v_exp_f32 v95, v95
    s_setprio 2
    buffer_load_dwordx4 v[200:203], v4, s[40:43], s58 offen offset:1536
    buffer_load_dwordx4 v[204:207], v4, s[40:43], s58 offen offset:2304
    s_add_u32 s58, s58, 4096
    buffer_load_dwordx4 v[188:191], v2, s[40:43], s58 offen
    s_add_u32 m0, s63, 81920
    s_add_u32 s56, s88, 460800
    s_mov_b32 exec_hi, 0xff
    buffer_load_dwordx4 v6, s[32:35], s56 offen lds
    s_add_u32 m0, s63, 87040
    s_add_u32 s56, s89, 409600
    buffer_load_dwordx4 v6, s[32:35], s56 offen lds
    s_mov_b32 exec_hi, -1
    s_cmp_eq_u32 s81, 3
    s_cbranch_scc0 L_blk7
    buffer_load_dwordx4 v[232:235], v2, s[40:43], s60 offen sc1
    buffer_load_dword v236, v16, s[40:43], s61 offen sc1
L_blk7:
    s_waitcnt vmcnt(8)
    s_cbranch_vccz L_lk698
    s_setprio 3
L_lk698:
    v_smfmac_f32_32x32x32_bf16 v[166:181], v[208:211], v[86:93], v104
    v_exp_f32 v96, v96
    v_exp_f32 v97, v97
    v_exp_f32 v98, v98
    v_exp_f32 v99, v99
    v_exp_f32 v100, v100
    v_mfma_f32_32x32x16_bf16 v[54:69], v[194:197], v[22:25], v[54:69]
    v_exp_f32 v101, v101
    v_exp_f32 v38, v38
    v_exp_f32 v39, v39
    s_setprio 3
    v_smfmac_f32_32x32x32_bf16 v[166:181], v[212:215], v[94:101], v104
    v_exp_f32 v40, v40
    v_exp_f32 v41, v41
    v_exp_f32 v42, v42
    v_mfma_f32_32x32x4_2b_bf16 v[70:101], v[198:199], v[36:37], 0 cbsz:1 abid:1
    v_exp_f32 v43, v43
    v_exp_f32 v44, v44
    v_exp_f32 v45, v45
    v_exp_f32 v46, v46
    v_exp_f32 v47, v47
    v_exp_f32 v48, v48
    v_exp_f32 v49, v49
    v_exp_f32 v50, v50
    v_smfmac_f32_32x32x32_bf16 v[118:133], v[216:219], v[38:45], v104
    v_exp_f32 v51, v51
    v_exp_f32 v52, v52
    v_exp_f32 v53, v53
    v_exp_f32 v54, v54
    v_exp_f32 v55, v55
    v_smfmac_f32_32x32x32_bf16 v[118:133], v[220:223], v[46:53], v104
    v_exp_f32 v56, v56
    v_exp_f32 v57, v57
    v_exp_f32 v58, v58
    v_mfma_f32_32x32x16_bf16 v[70:85], v[194:197], v[26:29], v[70:85]
    v_exp_f32 v59, v59
    v_exp_f32 v60, v60
    v_exp_f32 v61, v61
    v_exp_f32 v62, v62
    v_exp_f32 v63, v63
    v_smfmac_f32_32x32x32_bf16 v[134:149], v[216:219], v[54:61], v104
    v_exp_f32 v64, v64
    v_exp_f32 v65, v65
    v_exp_f32 v66, v66
    v_exp_f32 v67, v67
    v_mfma_f32_32x32x16_bf16 v[86:101], v[194:197], v[30:33], v[86:101]
    v_exp_f32 v68, v68
    v_exp_f32 v69, v69
    v_exp_f32 v70, v70
    v_exp_f32 v71, v71
    v_smfmac_f32_32x32x32_bf16 v[134:149], v[220:223], v[62:69], v104
    v_exp_f32 v72, v72
    v_exp_f32 v73, v73
    v_exp_f32 v74, v74
    v_mfma_f32_32x32x4_2b_bf16 v[38:69], v[186:187], v[34:35], 0 cbsz:1 abid:0
    v_exp_f32 v75, v75
    v_exp_f32 v76, v76
    v_exp_f32 v77, v77
    v_exp_f32 v78, v78
    v_exp_f32 v79, v79
    v_exp_f32 v80, v80
    v_exp_f32 v81, v81
    v_exp_f32 v82, v82
    v_smfmac_f32_32x32x32_bf16 v[150:165], v[216:219], v[70:77], v104
    v_exp_f32 v83, v83
    v_exp_f32 v84, v84
    v_exp_f32 v85, v85
    v_exp_f32 v86, v86
    v_exp_f32 v87, v87
    v_smfmac_f32_32x32x32_bf16 v[150:165], v[220:223], v[78:85], v104
    v_exp_f32 v88, v88
    v_exp_f32 v89, v89
    v_exp_f32 v90, v90
    v_mfma_f32_32x32x16_bf16 v[38:53], v[182:185], v[18:21], v[38:53]
    v_exp_f32 v91, v91
    v_exp_f32 v92, v92
    v_exp_f32 v93, v93
    v_and_b32 v14, 15, v1
    v_lshlrev_b32 v14, 7, v14
    v_exp_f32 v94, v94
    v_exp_f32 v95, v95
    s_setprio 2
    buffer_load_dwordx4 v[208:211], v4, s[40:43], s58 offen offset:1536
    buffer_load_dwordx4 v[212:215], v4, s[40:43], s58 offen offset:2304
    s_add_u32 s58, s58, 28672
    s_and_b32 s58, s58, 0x3ffff
    s_and_b32 s54, s73, 0xff000000
    s_cbranch_scc1 L_slow7
L_back7:
    buffer_load_dwordx4 v[194:197], v2, s[40:43], s58 offen
    buffer_load_dwordx2 v[192:193], v3, s[40:43], s58 offen offset:1024
    s_add_u32 m0, s63, 92160
    s_add_u32 s56, s89, 460800
    s_mov_b32 exec_hi, 0xff
    buffer_load_dwordx4 v6, s[32:35], s56 offen lds
    s_add_u32 m0, s63, 97280
    s_min_u32 s56, s88, s89
    s_add_u32 s56, s56, 409600
    buffer_load_dwordx4 v7, s[32:35], s56 offen lds
    s_mov_b32 exec_hi, -1
    s_and_b32 s76, s76, 0xfffff800
    buffer_load_dword v15, v14, s[40:43], s76 offen sc1
    s_waitcnt vmcnt(9)
    s_cbranch_vccz L_lk762
    s_setprio 3
L_lk762:
    v_smfmac_f32_32x32x32_bf16 v[166:181], v[216:219], v[86:93], v104
    v_exp_f32 v96, v96
    v_exp_f32 v97, v97
    v_exp_f32 v98, v98
    v_exp_f32 v99, v99
    v_exp_f32 v100, v100
    v_mfma_f32_32x32x16_bf16 v[54:69], v[182:185], v[22:25], v[54:69]
    v_exp_f32 v101, v101
    v_exp_f32 v38, v38
    v_exp_f32 v39, v39
    s_setprio 3
    v_smfmac_f32_32x32x32_bf16 v[166:181], v[220:223], v[94:101], v104
    v_exp_f32 v40, v40
    v_exp_f32 v41, v41
    v_exp_f32 v42, v42
    v_mfma_f32_32x32x4_2b_bf16 v[70:101], v[186:187], v[36:37], 0 cbsz:1 abid:0
    v_exp_f32 v43, v43
    v_exp_f32 v44, v44
    v_exp_f32 v45, v45
    v_exp_f32 v46, v46
    v_exp_f32 v47, v47
    v_exp_f32 v48, v48
    v_exp_f32 v49, v49
    v_exp_f32 v50, v50
    v_smfmac_f32_32x32x32_bf16 v[118:133], v[200:203], v[38:45], v104
    v_exp_f32 v51, v51
    v_exp_f32 v52, v52
    v_exp_f32 v53, v53
    v_exp_f32 v54, v54
    v_exp_f32 v55, v55
    v_smfmac_f32_32x32x32_bf16 v[118:133], v[204:207], v[46:53], v104
    v_exp_f32 v56, v56
    v_exp_f32 v57, v57
    v_exp_f32 v58, v58
    v_mfma_f32_32x32x16_bf16 v[70:85], v[182:185], v[26:29], v[70:85]
    v_exp_f32 v59, v59
    v_exp_f32 v60, v60
    v_exp_f32 v61, v61
    v_exp_f32 v62, v62
    v_exp_f32 v63, v63
    v_smfmac_f32_32x32x32_bf16 v[134:149], v[200:203], v[54:61], v104
    v_exp_f32 v64, v64
    v_exp_f32 v65, v65
    v_exp_f32 v66, v66
    v_exp_f32 v67, v67
    v_mfma_f32_32x32x16_bf16 v[86:101], v[182:185], v[30:33], v[86:101]
    v_exp_f32 v68, v68
    v_exp_f32 v69, v69
    v_exp_f32 v70, v70
    v_exp_f32 v71, v71
    v_smfmac_f32_32x32x32_bf16 v[134:149], v[204:207], v[62:69], v104
    v_exp_f32 v72, v72
    v_exp_f32 v73, v73
    v_exp_f32 v74, v74
    v_mfma_f32_32x32x4_2b_bf16 v[38:69], v[186:187], v[34:35], 0 cbsz:1 abid:1
    v_exp_f32 v75, v75
    v_exp_f32 v76, v76
    v_exp_f32 v77, v77
    v_exp_f32 v78, v78
    v_exp_f32 v79, v79
    v_exp_f32 v80, v80
    v_exp_f32 v81, v81
    v_exp_f32 v82, v82
    v_smfmac_f32_32x32x32_bf16 v[150:165], v[200:203], v[70:77], v104
    v_exp_f32 v83, v83
    v_exp_f32 v84, v84
    v_exp_f32 v85, v85
    v_exp_f32 v86, v86
    v_exp_f32 v87, v87
    v_smfmac_f32_32x32x32_bf16 v[150:165], v[204:207], v[78:85], v104
    v_exp_f32 v88, v88
    v_exp_f32 v89, v89
    v_exp_f32 v90, v90
    v_mfma_f32_32x32x16_bf16 v[38:53], v[188:191], v[18:21], v[38:53]
    v_exp_f32 v91, v91
    v_exp_f32 v92, v92
    v_exp_f32 v93, v93
    v_exp_f32 v94, v94
    v_exp_f32 v95, v95
    s_setprio 2
    buffer_load_dwordx4 v[216:219], v4, s[40:43], s58 offen offset:1536
    buffer_load_dwordx4 v[220:223], v4, s[40:43], s58 offen offset:2304
    s_add_u32 s58, s58, 4096
    buffer_load_dwordx4 v[182:185], v2, s[40:43], s58 offen
    s_waitcnt vmcnt(6)
    s_cbranch_vccz L_lk826
    s_setprio 3
L_lk826:
    v_smfmac_f32_32x32x32_bf16 v[166:181], v[200:203], v[86:93], v104
    v_exp_f32 v96, v96
    v_exp_f32 v97, v97
    v_exp_f32 v98, v98
    v_exp_f32 v99, v99
    v_exp_f32 v100, v100
    v_mfma_f32_32x32x16_bf16 v[54:69], v[188:191], v[22:25], v[54:69]
    v_exp_f32 v101, v101
    v_exp_f32 v38, v38
    v_exp_f32 v39, v39
    s_setprio 3
    v_smfmac_f32_32x32x32_bf16 v[166:181], v[204:207], v[94:101], v104
    v_exp_f32 v40, v40
    v_exp_f32 v41, v41
    v_exp_f32 v42, v42
    v_mfma_f32_32x32x4_2b_bf16 v[70:101], v[192:193], v[34:35], 0 cbsz:1 abid:0
    v_exp_f32 v43, v43
    v_exp_f32 v44, v44
    v_exp_f32 v45, v45
    buffer_load_dwordx4 v[200:203], v4, s[40:43], s58 offen offset:1536
    v_exp_f32 v46, v46
    v_exp_f32 v47, v47
    v_exp_f32 v48, v48
    v_exp_f32 v49, v49
    buffer_load_dwordx4 v[204:207], v4, s[40:43], s58 offen offset:2304
    v_exp_f32 v50, v50
    v_smfmac_f32_32x32x32_bf16 v[118:133], v[208:211], v[38:45], v104
    v_exp_f32 v51, v51
    v_exp_f32 v52, v52
    v_exp_f32 v53, v53
    v_exp_f32 v54, v54
    v_exp_f32 v55, v55
    v_smfmac_f32_32x32x32_bf16 v[118:133], v[212:215], v[46:53], v104
    v_exp_f32 v56, v56
    v_exp_f32 v57, v57
    v_exp_f32 v58, v58
    v_mfma_f32_32x32x16_bf16 v[70:85], v[194:197], v[18:21], v[70:85]
    v_exp_f32 v59, v59
    v_exp_f32 v60, v60
    v_exp_f32 v61, v61
    v_exp_f32 v62, v62
    v_exp_f32 v63, v63
    v_smfmac_f32_32x32x32_bf16 v[134:149], v[208:211], v[54:61], v104
    v_exp_f32 v64, v64
    v_exp_f32 v65, v65
    v_exp_f32 v66, v66
    v_exp_f32 v67, v67
    v_mfma_f32_32x32x16_bf16 v[86:101], v[194:197], v[22:25], v[86:101]
    v_exp_f32 v68, v68
    v_exp_f32 v69, v69
    v_exp_f32 v70, v70
    v_exp_f32 v71, v71
    v_smfmac_f32_32x32x32_bf16 v[134:149], v[212:215], v[62:69], v104
    v_exp_f32 v72, v72
    v_exp_f32 v73, v73
    v_exp_f32 v74, v74
    s_waitcnt vmcnt(2)
    v_mfma_f32_32x32x4_2b_bf16 v[38:69], v[192:193], v[34:35], 0 cbsz:1 abid:1
    v_exp_f32 v75, v75
    v_exp_f32 v76, v76
    v_exp_f32 v77, v77
    v_exp_f32 v78, v78
    v_exp_f32 v79, v79
    v_exp_f32 v80, v80
    v_exp_f32 v81, v81
    v_exp_f32 v82, v82
    v_smfmac_f32_32x32x32_bf16 v[118:133], v[216:219], v[70:77], v104
    v_exp_f32 v83, v83
    v_exp_f32 v84, v84
    v_exp_f32 v85, v85
    v_exp_f32 v86, v86
    v_exp_f32 v87, v87
    v_smfmac_f32_32x32x32_bf16 v[118:133], v[220:223], v[78:85], v104
    v_exp_f32 v88, v88
    v_exp_f32 v89, v89
    v_exp_f32 v90, v90
    v_mfma_f32_32x32x16_bf16 v[38:53], v[182:185], v[18:21], v[38:53]
    v_exp_f32 v91, v91
    v_exp_f32 v92, v92
    v_exp_f32 v93, v93
    v_exp_f32 v94, v94
    v_exp_f32 v95, v95
    s_lshl_b32 s54, s45, 1
    s_add_u32 s54, s54, s46
    s_add_u32 s54, s54, 153888
    v_mov_b32 v5, s54
    v_mov_b32 v13, 1
    v_and_b32 v7, -4, v5
    v_mov_b32 v6, 153888
    s_mul_i32 s55, s82, 20480
    s_sub_u32 s70, s60, s55
    s_sub_u32 s71, s61, s55
    s_lshl_b32 s55, s82, 1
    v_subrev_u32 v248, s55, v5
    s_mul_i32 s55, s46, -9216
    s_add_u32 s55, s55, 24064
    s_mul_i32 s55, s55, s82
    v_add_u32 v255, s55, v9
    s_mul_i32 s55, s69, 9216
    v_add_u32 v249, s55, v10
    v_xor_b32 v252, 1, v5
    v_smfmac_f32_32x32x32_bf16 v[134:149], v[216:219], v[86:93], v104
    v_exp_f32 v96, v96
    v_exp_f32 v97, v97
    v_exp_f32 v98, v98
    v_exp_f32 v99, v99
    v_exp_f32 v100, v100
    v_mfma_f32_32x32x16_bf16 v[54:69], v[182:185], v[22:25], v[54:69]
    v_exp_f32 v101, v101
    v_exp_f32 v38, v38
    v_exp_f32 v39, v39
    v_smfmac_f32_32x32x32_bf16 v[134:149], v[220:223], v[94:101], v104
    v_exp_f32 v40, v40
    v_exp_f32 v41, v41
    v_exp_f32 v42, v42
    v_mfma_f32_32x32x4_2b_bf16 v[70:101], v[186:187], v[36:37], 0 cbsz:1 abid:1
    v_exp_f32 v43, v43
    v_exp_f32 v44, v44
    v_exp_f32 v45, v45
    v_exp_f32 v46, v46
    v_exp_f32 v47, v47
    v_exp_f32 v48, v48
    v_exp_f32 v49, v49
    v_exp_f32 v50, v50
    s_waitcnt vmcnt(0)
    v_smfmac_f32_32x32x32_bf16 v[118:133], v[200:203], v[38:45], v104
    v_exp_f32 v51, v51
    v_exp_f32 v52, v52
    v_exp_f32 v53, v53
L_f2:
    v_xor_b32 v15, s51, v15
    v_cmp_lt_u32 vcc, 7, v15
    s_cbranch_vccnz L_slowf2
    v_cmp_ne_u32 s[72:73], s59, v15
    s_mov_b64 exec, 1
    ds_write_b8 v5, v13 offset:16
    s_mov_b64 exec, -1
    v_exp_f32 v54, v54
    v_exp_f32 v55, v55
    v_smfmac_f32_32x32x32_bf16 v[118:133], v[204:207], v[46:53], v104
    v_exp_f32 v56, v56
    v_exp_f32 v57, v57
    v_exp_f32 v58, v58
    v_mfma_f32_32x32x16_bf16 v[70:85], v[188:191], v[26:29], v[70:85]
    v_exp_f32 v59, v59
    v_exp_f32 v60, v60
    v_exp_f32 v61, v61
    v_exp_f32 v62, v62
    v_exp_f32 v63, v63
    v_smfmac_f32_32x32x32_bf16 v[134:149], v[200:203], v[54:61], v104
    v_exp_f32 v64, v64
    v_exp_f32 v65, v65
    v_exp_f32 v66, v66
    v_exp_f32 v67, v67
    v_mfma_f32_32x32x16_bf16 v[86:101], v[188:191], v[30:33], v[86:101]
    v_exp_f32 v68, v68
    v_exp_f32 v69, v69
    v_exp_f32 v70, v70
    v_exp_f32 v71, v71
    v_smfmac_f32_32x32x32_bf16 v[134:149], v[204:207], v[62:69], v104
    v_exp_f32 v72, v72
    ds_write_b128 v11, v[118:121] offset:0
    ds_write_b128 v11, v[122:125] offset:1024
    ds_write_b128 v11, v[126:129] offset:2048
    v_exp_f32 v73, v73
    v_exp_f32 v74, v74
    v_mfma_f32_32x32x4_2b_bf16 v[38:69], v[192:193], v[36:37], 0 cbsz:1 abid:0
    v_exp_f32 v75, v75
    v_exp_f32 v76, v76
    v_exp_f32 v77, v77
    v_exp_f32 v78, v78
    s_cmp_eq_u32 s69, 1
    s_cbranch_scc0 L_blk8
    ds_write_b128 v9, v[134:137] offset:3072
    ds_write_b128 v9, v[138:141] offset:4096
    ds_write_b128 v9, v[142:145] offset:5120
L_blk8:
    s_mov_b64 exec, 1
    ds_write_b8 v5, v13 offset:8
    s_mov_b64 exec, -1
    s_cmp_eq_u32 s69, 0
    s_cbranch_scc0 L_blk9
L_eslow:
    ds_read_b32 v14, v7 offset:8
    s_add_u32 s64, s64, 1
    s_cmp_lt_u32 s64, 1000000
    s_cbranch_scc0 L_end
    s_waitcnt lgkmcnt(0)
    v_cmp_ne_u32 vcc, 0x01010101, v14
    s_cbranch_vccnz L_eslow
    ds_read_b128 v[224:227], v9 offset:0
    ds_read_b128 v[228:231], v9 offset:1024
    ds_read_b128 v[232:235], v9 offset:2048
    ds_read_b128 v[236:239], v9 offset:3072
    ds_read_b128 v[240:243], v9 offset:4096
    ds_read_b128 v[244:247], v9 offset:5120
    ds_read_b128 v[118:121], v9 offset:6144
    ds_read_b128 v[122:125], v9 offset:7168
    ds_read_b128 v[126:129], v9 offset:8192
    s_waitcnt lgkmcnt(3)
    v_add_f32 v134, v134, v224
    v_add_f32 v135, v135, v225
    v_add_f32 v136, v136, v226
    v_add_f32 v137, v137, v227
    v_add_f32 v138, v138, v228
    v_add_f32 v139, v139, v229
    v_add_f32 v140, v140, v230
    v_add_f32 v141, v141, v231
    v_add_f32 v142, v142, v232
    v_add_f32 v143, v143, v233
    v_add_f32 v144, v144, v234
    v_add_f32 v134, v134, v236
    v_add_f32 v135, v135, v237
    v_add_f32 v136, v136, v238
    v_add_f32 v137, v137, v239
    v_add_f32 v138, v138, v240
    v_add_f32 v139, v139, v241
    v_add_f32 v140, v140, v242
    v_add_f32 v141, v141, v243
    v_add_f32 v142, v142, v244
    v_add_f32 v143, v143, v245
    v_add_f32 v144, v144, v246
    s_waitcnt lgkmcnt(0)
    v_add_f32 v134, v134, v118
    v_add_f32 v135, v135, v119
    v_add_f32 v136, v136, v120
    v_add_f32 v137, v137, v121
    v_add_f32 v138, v138, v122
    v_add_f32 v139, v139, v123
    v_add_f32 v140, v140, v124
    v_add_f32 v141, v141, v125
    v_add_f32 v142, v142, v126
    v_add_f32 v143, v143, v127
    v_add_f32 v144, v144, v128
    v_subrev_u32 v236, 0x21800000, v144
    v_cmp_lt_u32 vcc, 0x3c000000, v236
    s_cbranch_vccnz L_defer
    v_rcp_f32 v144, v144
    s_or_b32 s54, s72, s73
    v_mul_f32 v134, v134, v144
    v_mul_f32 v135, v135, v144
    v_mul_f32 v136, v136, v144
    v_mul_f32 v137, v137, v144
    v_mul_f32 v138, v138, v144
    v_mul_f32 v139, v139, v144
    v_mul_f32 v140, v140, v144
    v_mul_f32 v141, v141, v144
    v_mul_f32 v142, v142, v144
    v_mul_f32 v143, v143, v144
    v_cvt_pk_bf16_f32 v236, v134, v135
    v_cvt_pk_bf16_f32 v237, v136, v137
    v_cvt_pk_bf16_f32 v238, v138, v139
    v_cvt_pk_bf16_f32 v239, v140, v141
    v_cvt_pk_bf16_f32 v240, v142, v143
L_oste:
    s_cbranch_scc1 L_osce
    buffer_store_dwordx4 v[236:239], v2, s[40:43], s70 offen
    buffer_store_dword v240, v16, s[40:43], s71 offen
L_osde:
    s_mov_b64 exec, 1
    ds_write_b8 v248, v13 offset:24
    s_mov_b64 exec, -1
L_deferred:
L_blk9:
    s_setprio 1
    v_exp_f32 v79, v79
    v_exp_f32 v80, v80
    v_exp_f32 v81, v81
    v_exp_f32 v82, v82
    v_smfmac_f32_32x32x32_bf16 v[150:165], v[208:211], v[70:77], v104
    v_exp_f32 v83, v83
    v_exp_f32 v84, v84
    v_exp_f32 v85, v85
    v_exp_f32 v86, v86
    v_exp_f32 v87, v87
    v_smfmac_f32_32x32x32_bf16 v[150:165], v[212:215], v[78:85], v104
    v_exp_f32 v88, v88
    v_exp_f32 v89, v89
    v_exp_f32 v90, v90
    v_mfma_f32_32x32x16_bf16 v[38:53], v[194:197], v[26:29], v[38:53]
    v_exp_f32 v91, v91
    v_exp_f32 v92, v92
    v_exp_f32 v93, v93
    v_exp_f32 v94, v94
    v_exp_f32 v95, v95
    v_smfmac_f32_32x32x32_bf16 v[166:181], v[208:211], v[86:93], v104
    v_exp_f32 v96, v96
    v_exp_f32 v97, v97
    v_exp_f32 v98, v98
    v_exp_f32 v99, v99
    v_exp_f32 v100, v100
    v_mfma_f32_32x32x16_bf16 v[54:69], v[194:197], v[30:33], v[54:69]
    v_exp_f32 v101, v101
    v_exp_f32 v38, v38
    v_exp_f32 v39, v39
    v_smfmac_f32_32x32x32_bf16 v[166:181], v[212:215], v[94:101], v104
    v_exp_f32 v40, v40
    v_exp_f32 v41, v41
    v_exp_f32 v42, v42
    v_mfma_f32_32x32x4_2b_bf16 v[70:101], v[192:193], v[36:37], 0 cbsz:1 abid:1
    v_exp_f32 v43, v43
    v_exp_f32 v44, v44
    v_exp_f32 v45, v45
    v_exp_f32 v46, v46
    v_exp_f32 v47, v47
    v_exp_f32 v48, v48
    v_exp_f32 v49, v49
    v_exp_f32 v50, v50
    v_smfmac_f32_32x32x32_bf16 v[150:165], v[216:219], v[38:45], v104
    v_exp_f32 v51, v51
    v_exp_f32 v52, v52
    v_exp_f32 v53, v53
    v_exp_f32 v54, v54
    v_exp_f32 v55, v55
    v_smfmac_f32_32x32x32_bf16 v[150:165], v[220:223], v[46:53], v104
    v_exp_f32 v56, v56
    v_exp_f32 v57, v57
    v_exp_f32 v58, v58
    v_mfma_f32_32x32x16_bf16 v[70:85], v[182:185], v[26:29], v[70:85]
    v_exp_f32 v59, v59
    v_exp_f32 v60, v60
    v_exp_f32 v61, v61
    v_exp_f32 v62, v62
    v_exp_f32 v63, v63
    v_smfmac_f32_32x32x32_bf16 v[166:181], v[216:219], v[54:61], v104
    v_exp_f32 v64, v64
    v_exp_f32 v65, v65
    v_exp_f32 v66, v66
    v_exp_f32 v67, v67
    v_mfma_f32_32x32x16_bf16 v[86:101], v[182:185], v[30:33], v[86:101]
    v_exp_f32 v68, v68
    v_exp_f32 v69, v69
    v_exp_f32 v70, v70
    v_exp_f32 v71, v71
    v_smfmac_f32_32x32x32_bf16 v[166:181], v[220:223], v[62:69], v104
    v_exp_f32 v72, v72
    v_exp_f32 v73, v73
    v_exp_f32 v74, v74
    v_exp_f32 v75, v75
    v_exp_f32 v76, v76
    v_exp_f32 v77, v77
    v_exp_f32 v78, v78
    v_exp_f32 v79, v79
    v_exp_f32 v80, v80
    v_exp_f32 v81, v81
    v_exp_f32 v82, v82
    v_smfmac_f32_32x32x32_bf16 v[150:165], v[200:203], v[70:77], v104
    v_exp_f32 v83, v83
    v_exp_f32 v84, v84
    v_exp_f32 v85, v85
    v_exp_f32 v86, v86
    v_exp_f32 v87, v87
    v_smfmac_f32_32x32x32_bf16 v[150:165], v[204:207], v[78:85], v104
    v_exp_f32 v88, v88
    v_exp_f32 v89, v89
    v_exp_f32 v90, v90
    v_exp_f32 v91, v91
    v_exp_f32 v92, v92
    v_exp_f32 v93, v93
    v_exp_f32 v94, v94
    v_exp_f32 v95, v95
    v_smfmac_f32_32x32x32_bf16 v[166:181], v[200:203], v[86:93], v104
    v_exp_f32 v96, v96
    ds_write_b128 v12, v[150:153] offset:0
    ds_write_b128 v12, v[154:157] offset:1024
    ds_write_b128 v12, v[158:161] offset:2048
    s_mov_b64 exec, 1
    ds_write_b8 v5, v13 offset:0
    s_mov_b64 exec, -1
    v_exp_f32 v97, v97
    v_exp_f32 v98, v98
    v_exp_f32 v99, v99
    v_exp_f32 v100, v100
    v_exp_f32 v101, v101
    s_nop 1
    v_smfmac_f32_32x32x32_bf16 v[166:181], v[204:207], v[94:101], v104
    s_cmp_eq_u32 s82, 1
    s_cbranch_scc0 L_blk10
    s_cmp_eq_u32 s83, 1
    s_cbranch_scc0 L_blk11
    ds_read_u8 v247, v5 offset:46
    ds_read_b128 v[224:227], v255 offset:3072
    ds_read_b128 v[228:231], v255 offset:4096
    ds_read_b128 v[232:235], v255 offset:5120
L_blk11:
    ds_read_u8 v246, v252
    ds_read_b128 v[118:121], v249 offset:0
    ds_read_b128 v[122:125], v249 offset:1024
    ds_read_b128 v[126:129], v249 offset:2048
L_blk10:
    s_cmp_eq_u32 s45, 3
    s_cbranch_scc0 L_other
L_t3:
    s_waitcnt lgkmcnt(0)
    v_and_b32 v246, v246, v247
    v_cmp_ne_u32 vcc, 1, v246
    s_cbranch_vccnz L_t3w
    v_add_f32 v118, v118, v224
    v_add_f32 v119, v119, v225
    v_add_f32 v120, v120, v226
    v_add_f32 v121, v121, v227
    v_add_f32 v122, v122, v228
    v_add_f32 v123, v123, v229
    v_add_f32 v124, v124, v230
    v_add_f32 v125, v125, v231
    v_add_f32 v126, v126, v232
    v_add_f32 v127, v127, v233
    v_add_f32 v128, v128, v234
    v_add_f32 v166, v166, v118
    v_add_f32 v167, v167, v119
    v_add_f32 v168, v168, v120
    v_add_f32 v169, v169, v121
    v_add_f32 v170, v170, v122
    v_add_f32 v171, v171, v123
    v_add_f32 v172, v172, v124
    v_add_f32 v173, v173, v125
    v_add_f32 v174, v174, v126
    v_add_f32 v175, v175, v127
    v_add_f32 v176, v176, v128
    v_subrev_u32 v118, 0x21800000, v176
    v_cmp_lt_u32 vcc, 0x3c000000, v118
    s_cbranch_vccnz L_fallback
    v_rcp_f32 v176, v176
    s_or_b32 s54, s72, s73
    v_mul_f32 v166, v166, v176
    v_mul_f32 v167, v167, v176
    v_mul_f32 v168, v168, v176
    v_mul_f32 v169, v169, v176
    v_mul_f32 v170, v170, v176
    v_mul_f32 v171, v171, v176
    v_mul_f32 v172, v172, v176
    v_mul_f32 v173, v173, v176
    v_mul_f32 v174, v174, v176
    v_mul_f32 v175, v175, v176
    v_cvt_pk_bf16_f32 v236, v166, v167
    v_cvt_pk_bf16_f32 v237, v168, v169
    v_cvt_pk_bf16_f32 v238, v170, v171
    v_cvt_pk_bf16_f32 v239, v172, v173
    v_cvt_pk_bf16_f32 v240, v174, v175
L_ostl:
    s_cbranch_scc1 L_oscl
    buffer_store_dwordx4 v[236:239], v2, s[40:43], s60 offen
    buffer_store_dword v240, v16, s[40:43], s61 offen
L_osdl:
    s_mov_b64 exec, 1
    ds_write_b8 v5, v13 offset:24
    s_mov_b64 exec, -1
    s_cmp_eq_u32 s85, 0
    s_cbranch_scc0 L_dfb
L_role:
    s_cmp_eq_u32 s82, 0
    s_cbranch_scc1 L_work
    s_setprio 0
    s_mov_b32 exec_hi, 0xff
L_rw0:
    ds_read_b32 v246, v6 offset:32
    s_add_u32 s64, s64, 1
    s_cmp_lt_u32 s64, 1000000
    s_cbranch_scc0 L_end
    s_waitcnt lgkmcnt(0)
    v_cmp_ne_u32 vcc, 0x01010101, v246
    s_cbranch_vccnz L_rw0
    ds_read_b128 v[118:121], v250 offset:0
    ds_read_b128 v[122:125], v250 offset:25600
    ds_read_b128 v[126:129], v251 offset:0
    ds_read_b128 v[130:133], v251 offset:25600
    ds_read_b128 v[134:137], v250 offset:2816
    ds_read_b128 v[18:21], v250 offset:28416
    ds_read_b128 v[22:25], v251 offset:2816
    ds_read_b128 v[26:29], v251 offset:28416
L_rd0:
    s_add_u32 s55, s65, 0
    s_waitcnt lgkmcnt(6)
    v_add_f32 v118, v118, v122
    v_add_f32 v119, v119, v123
    v_add_f32 v120, v120, v124
    v_add_f32 v121, v121, v125
    s_waitcnt lgkmcnt(4)
    v_add_f32 v126, v126, v130
    v_add_f32 v127, v127, v131
    v_add_f32 v128, v128, v132
    v_add_f32 v129, v129, v133
    v_add_f32 v118, v118, v126
    v_add_f32 v119, v119, v127
    v_add_f32 v120, v120, v128
    v_add_f32 v121, v121, v129
    v_cvt_pk_bf16_f32 v30, v118, v119
    v_cvt_pk_bf16_f32 v31, v120, v121
    s_waitcnt lgkmcnt(2)
    v_add_f32 v134, v134, v18
    v_add_f32 v135, v135, v19
    v_add_f32 v136, v136, v20
    v_add_f32 v137, v137, v21
    s_waitcnt lgkmcnt(0)
    v_add_f32 v22, v22, v26
    v_add_f32 v23, v23, v27
    v_add_f32 v24, v24, v28
    v_add_f32 v25, v25, v29
    v_add_f32 v134, v134, v22
    v_add_f32 v135, v135, v23
    v_add_f32 v136, v136, v24
    v_add_f32 v137, v137, v25
    v_cvt_pk_bf16_f32 v32, v134, v135
    v_cvt_pk_bf16_f32 v33, v136, v137
    buffer_store_dwordx4 v[30:33], v253, s[36:39], s55 offen
    s_mov_b32 exec_hi, -1
    s_mov_b32 exec_hi, 0xff
L_rw2:
    ds_read_b32 v246, v6 offset:40
    s_add_u32 s64, s64, 1
    s_cmp_lt_u32 s64, 1000000
    s_cbranch_scc0 L_end
    s_waitcnt lgkmcnt(0)
    v_cmp_ne_u32 vcc, 0x01010101, v246
    s_cbranch_vccnz L_rw2
    ds_read_b128 v[38:41], v250 offset:11264
    ds_read_b128 v[42:45], v250 offset:36864
    ds_read_b128 v[46:49], v251 offset:11264
    ds_read_b128 v[50:53], v251 offset:36864
    ds_read_b128 v[54:57], v250 offset:14080
    ds_read_b128 v[58:61], v250 offset:39680
    ds_read_b128 v[62:65], v251 offset:14080
    ds_read_b128 v[66:69], v251 offset:39680
L_rd2:
    s_add_u32 s55, s65, 40960
    s_waitcnt lgkmcnt(6)
    v_add_f32 v38, v38, v42
    v_add_f32 v39, v39, v43
    v_add_f32 v40, v40, v44
    v_add_f32 v41, v41, v45
    s_waitcnt lgkmcnt(4)
    v_add_f32 v46, v46, v50
    v_add_f32 v47, v47, v51
    v_add_f32 v48, v48, v52
    v_add_f32 v49, v49, v53
    v_add_f32 v38, v38, v46
    v_add_f32 v39, v39, v47
    v_add_f32 v40, v40, v48
    v_add_f32 v41, v41, v49
    v_cvt_pk_bf16_f32 v70, v38, v39
    v_cvt_pk_bf16_f32 v71, v40, v41
    s_waitcnt lgkmcnt(2)
    v_add_f32 v54, v54, v58
    v_add_f32 v55, v55, v59
    v_add_f32 v56, v56, v60
    v_add_f32 v57, v57, v61
    s_waitcnt lgkmcnt(0)
    v_add_f32 v62, v62, v66
    v_add_f32 v63, v63, v67
    v_add_f32 v64, v64, v68
    v_add_f32 v65, v65, v69
    v_add_f32 v54, v54, v62
    v_add_f32 v55, v55, v63
    v_add_f32 v56, v56, v64
    v_add_f32 v57, v57, v65
    v_cvt_pk_bf16_f32 v72, v54, v55
    v_cvt_pk_bf16_f32 v73, v56, v57
    buffer_store_dwordx4 v[70:73], v253, s[36:39], s55 offen
    s_mov_b32 exec_hi, -1
    s_mov_b32 exec_hi, 0xff
L_rw1:
    ds_read_b32 v246, v6 offset:36
    s_add_u32 s64, s64, 1
    s_cmp_lt_u32 s64, 1000000
    s_cbranch_scc0 L_end
    s_waitcnt lgkmcnt(0)
    v_cmp_ne_u32 vcc, 0x01010101, v246
    s_cbranch_vccnz L_rw1
    ds_read_b128 v[118:121], v250 offset:5632
    ds_read_b128 v[122:125], v250 offset:31232
    ds_read_b128 v[126:129], v251 offset:5632
    ds_read_b128 v[130:133], v251 offset:31232
    ds_read_b128 v[134:137], v250 offset:8448
    ds_read_b128 v[18:21], v250 offset:34048
    ds_read_b128 v[22:25], v251 offset:8448
    ds_read_b128 v[26:29], v251 offset:34048
L_rd1:
    s_add_u32 s55, s65, 20480
    s_waitcnt lgkmcnt(6)
    v_add_f32 v118, v118, v122
    v_add_f32 v119, v119, v123
    v_add_f32 v120, v120, v124
    v_add_f32 v121, v121, v125
    s_waitcnt lgkmcnt(4)
    v_add_f32 v126, v126, v130
    v_add_f32 v127, v127, v131
    v_add_f32 v128, v128, v132
    v_add_f32 v129, v129, v133
    v_add_f32 v118, v118, v126
    v_add_f32 v119, v119, v127
    v_add_f32 v120, v120, v128
    v_add_f32 v121, v121, v129
    v_cvt_pk_bf16_f32 v30, v118, v119
    v_cvt_pk_bf16_f32 v31, v120, v121
    s_waitcnt lgkmcnt(2)
    v_add_f32 v134, v134, v18
    v_add_f32 v135, v135, v19
    v_add_f32 v136, v136, v20
    v_add_f32 v137, v137, v21
    s_waitcnt lgkmcnt(0)
    v_add_f32 v22, v22, v26
    v_add_f32 v23, v23, v27
    v_add_f32 v24, v24, v28
    v_add_f32 v25, v25, v29
    v_add_f32 v134, v134, v22
    v_add_f32 v135, v135, v23
    v_add_f32 v136, v136, v24
    v_add_f32 v137, v137, v25
    v_cvt_pk_bf16_f32 v32, v134, v135
    v_cvt_pk_bf16_f32 v33, v136, v137
    buffer_store_dwordx4 v[30:33], v253, s[36:39], s55 offen
    s_mov_b32 exec_hi, -1
    s_mov_b32 exec_hi, 0xff
L_rw3:
    ds_read_b32 v246, v6 offset:44
    s_add_u32 s64, s64, 1
    s_cmp_lt_u32 s64, 1000000
    s_cbranch_scc0 L_end
    s_waitcnt lgkmcnt(0)
    v_cmp_ne_u32 vcc, 0x01010101, v246
    s_cbranch_vccnz L_rw3
    ds_read_b128 v[38:41], v250 offset:16896
    ds_read_b128 v[42:45], v250 offset:42496
    ds_read_b128 v[46:49], v251 offset:16896
    ds_read_b128 v[50:53], v251 offset:42496
    ds_read_b128 v[54:57], v250 offset:19712
    ds_read_b128 v[58:61], v250 offset:45312
    ds_read_b128 v[62:65], v251 offset:19712
    ds_read_b128 v[66:69], v251 offset:45312
L_rd3:
    s_add_u32 s55, s65, 61440
    s_waitcnt lgkmcnt(6)
    v_add_f32 v38, v38, v42
    v_add_f32 v39, v39, v43
    v_add_f32 v40, v40, v44
    v_add_f32 v41, v41, v45
    s_waitcnt lgkmcnt(4)
    v_add_f32 v46, v46, v50
    v_add_f32 v47, v47, v51
    v_add_f32 v48, v48, v52
    v_add_f32 v49, v49, v53
    v_add_f32 v38, v38, v46
    v_add_f32 v39, v39, v47
    v_add_f32 v40, v40, v48
    v_add_f32 v41, v41, v49
    v_cvt_pk_bf16_f32 v70, v38, v39
    v_cvt_pk_bf16_f32 v71, v40, v41
    s_waitcnt lgkmcnt(2)
    v_add_f32 v54, v54, v58
    v_add_f32 v55, v55, v59
    v_add_f32 v56, v56, v60
    v_add_f32 v57, v57, v61
    s_waitcnt lgkmcnt(0)
    v_add_f32 v62, v62, v66
    v_add_f32 v63, v63, v67
    v_add_f32 v64, v64, v68
    v_add_f32 v65, v65, v69
    v_add_f32 v54, v54, v62
    v_add_f32 v55, v55, v63
    v_add_f32 v56, v56, v64
    v_add_f32 v57, v57, v65
    v_cvt_pk_bf16_f32 v72, v54, v55
    v_cvt_pk_bf16_f32 v73, v56, v57
    buffer_store_dwordx4 v[70:73], v253, s[36:39], s55 offen
    s_mov_b32 exec_hi, -1
L_fin:
    s_or_b32 s54, s2, s44
    s_cmp_eq_u32 s54, 0
    s_cbranch_scc0 L_noep
    s_mov_b64 exec, 1
    v_mov_b32 v15, s51
    v_mov_b32 v14, 327680
    buffer_store_dword v15, v14, s[40:43], 0 offen sc1
    s_mov_b64 exec, -1
L_noep:
L_end:
    s_endpgm
L_t3w:
    s_add_u32 s64, s64, 1
    s_cmp_lt_u32 s64, 1000000
    s_cbranch_scc0 L_end
    ds_read_u8 v247, v5 offset:46
    ds_read_b128 v[224:227], v255 offset:3072
    ds_read_b128 v[228:231], v255 offset:4096
    ds_read_b128 v[232:235], v255 offset:5120
    ds_read_u8 v246, v252
    ds_read_b128 v[118:121], v249 offset:0
    ds_read_b128 v[122:125], v249 offset:1024
    ds_read_b128 v[126:129], v249 offset:2048
    s_branch L_t3
L_t2w:
    s_add_u32 s64, s64, 1
    s_cmp_lt_u32 s64, 1000000
    s_cbranch_scc0 L_end
    ds_read_u8 v246, v252
    ds_read_b128 v[118:121], v249 offset:0
    ds_read_b128 v[122:125], v249 offset:1024
    ds_read_b128 v[126:129], v249 offset:2048
L_t2:
    s_waitcnt lgkmcnt(0)
    v_cmp_ne_u32 vcc, 1, v246
    s_cbranch_vccnz L_t2w
    s_nop 4
    v_add_f32 v166, v166, v118
    v_add_f32 v167, v167, v119
    v_add_f32 v168, v168, v120
    v_add_f32 v169, v169, v121
    v_add_f32 v170, v170, v122
    v_add_f32 v171, v171, v123
    v_add_f32 v172, v172, v124
    v_add_f32 v173, v173, v125
    v_add_f32 v174, v174, v126
    v_add_f32 v175, v175, v127
    v_add_f32 v176, v176, v128
    ds_write_b128 v255, v[166:169] offset:3072
    ds_write_b128 v255, v[170:173] offset:4096
    ds_write_b128 v255, v[174:177] offset:5120
    s_mov_b64 exec, 1
    ds_write_b8 v5, v13 offset:48
    s_mov_b64 exec, -1
    s_branch L_role
    s_endpgm
    s_endpgm
    s_endpgm
    s_endpgm
    s_endpgm
    s_endpgm
    s_endpgm
    s_endpgm
    s_endpgm
    s_endpgm
    s_endpgm
    s_endpgm
    s_endpgm
    s_endpgm
    s_endpgm
    s_endpgm
    s_endpgm
    s_endpgm
    s_endpgm
    s_endpgm
    s_endpgm
    s_endpgm
    s_endpgm
    s_endpgm
    s_endpgm
    s_endpgm
    s_endpgm
    s_endpgm
L_other:
    s_cmp_eq_u32 s45, 2
    s_cbranch_scc1 L_t2
    s_cmp_eq_u32 s45, 0
    s_cbranch_scc1 L_t0
L_ws0:
    ds_read_b64 v[14:15], v6 offset:16
    ds_read_b64_tr_b16 v[38:39], v8 offset:0
    ds_read_b64_tr_b16 v[40:41], v8 offset:2560
    ds_read_b64_tr_b16 v[42:43], v8 offset:32
    ds_read_b64_tr_b16 v[44:45], v8 offset:2592
    ds_read_b64_tr_b16 v[46:47], v8 offset:64
    ds_read_b64_tr_b16 v[48:49], v8 offset:2624
    ds_read_b64_tr_b16 v[50:51], v8 offset:96
    ds_read_b64_tr_b16 v[52:53], v8 offset:2656
    s_waitcnt lgkmcnt(8)
    v_and_b32 v14, v14, v15
    v_cmp_ne_u32 vcc, 0x01010101, v14
    s_cbranch_vccnz L_wr0
    buffer_load_dwordx4 v[118:121], v2, s[40:43], s67 offen sc1
    buffer_load_dwordx4 v[122:125], v2, s[40:43], s67 offen offset:1024 sc1
    buffer_load_dwordx2 v[134:135], v16, s[40:43], s67 offen offset:2048 sc1
    buffer_load_dwordx4 v[126:129], v2, s[40:43], s68 offen sc1
    buffer_load_dwordx4 v[130:133], v2, s[40:43], s68 offen offset:1024 sc1
    buffer_load_dwordx2 v[136:137], v16, s[40:43], s68 offen offset:2048 sc1
    ds_read_b64_tr_b16 v[54:55], v8 offset:128
    ds_read_b64_tr_b16 v[56:57], v8 offset:2688
    ds_read_b64_tr_b16 v[58:59], v8 offset:5120
    ds_read_b64_tr_b16 v[60:61], v8 offset:7680
    ds_read_b64_tr_b16 v[62:63], v8 offset:5152
    ds_read_b64_tr_b16 v[64:65], v8 offset:7712
    ds_read_b64_tr_b16 v[66:67], v8 offset:5184
    ds_read_b64_tr_b16 v[68:69], v8 offset:7744
    ds_read_b64_tr_b16 v[70:71], v8 offset:5216
    ds_read_b64_tr_b16 v[72:73], v8 offset:7776
    ds_read_b64_tr_b16 v[74:75], v8 offset:5248
    ds_read_b64_tr_b16 v[76:77], v8 offset:7808
    ds_read_b64_tr_b16 v[78:79], v8 offset:10240
    ds_read_b64_tr_b16 v[80:81], v8 offset:12800
    ds_read_b64_tr_b16 v[82:83], v8 offset:10272
    ds_read_b64_tr_b16 v[84:85], v8 offset:12832
    ds_read_b64_tr_b16 v[86:87], v8 offset:10304
    ds_read_b64_tr_b16 v[88:89], v8 offset:12864
    ds_read_b64_tr_b16 v[90:91], v8 offset:10336
    ds_read_b64_tr_b16 v[92:93], v8 offset:12896
    ds_read_b64_tr_b16 v[94:95], v8 offset:10368
    ds_read_b64_tr_b16 v[96:97], v8 offset:12928
    ds_read_b64_tr_b16 v[98:99], v8 offset:15360
    ds_read_b64_tr_b16 v[100:101], v8 offset:17920
    ds_read_b64_tr_b16 v[102:103], v8 offset:15392
    ds_read_b64_tr_b16 v[104:105], v8 offset:17952
    ds_read_b64_tr_b16 v[106:107], v8 offset:15424
    ds_read_b64_tr_b16 v[108:109], v8 offset:17984
    ds_read_b64_tr_b16 v[110:111], v8 offset:15456
    ds_read_b64_tr_b16 v[112:113], v8 offset:18016
    ds_read_b64_tr_b16 v[114:115], v8 offset:15488
    ds_read_b64_tr_b16 v[116:117], v8 offset:18048
    ds_read_b64_tr_b16 v[138:139], v8 offset:20480
    ds_read_b64_tr_b16 v[140:141], v8 offset:23040
    ds_read_b64_tr_b16 v[142:143], v8 offset:20512
    ds_read_b64_tr_b16 v[144:145], v8 offset:23072
    ds_read_b64_tr_b16 v[146:147], v8 offset:20544
    ds_read_b64_tr_b16 v[148:149], v8 offset:23104
    ds_read_b64_tr_b16 v[150:151], v8 offset:20576
    ds_read_b64_tr_b16 v[152:153], v8 offset:23136
    ds_read_b64_tr_b16 v[154:155], v8 offset:20608
    ds_read_b64_tr_b16 v[156:157], v8 offset:23168
    ds_read_b32 v246, v7
    ds_read_b128 v[182:185], v10 offset:0
    ds_read_b128 v[186:189], v10 offset:1024
    ds_read_b128 v[190:193], v10 offset:2048
    ds_read_b128 v[208:211], v10 offset:9216
    ds_read_b128 v[212:215], v10 offset:10240
    ds_read_b128 v[216:219], v10 offset:11264
    ds_read_u8 v247, v5 offset:46
    ds_read_b128 v[224:227], v255 offset:3072
    ds_read_b128 v[228:231], v255 offset:4096
    ds_read_b128 v[232:235], v255 offset:5120
L_lrd:
    s_waitcnt lgkmcnt(4)
    v_cmp_ne_u32 vcc, 0x01010101, v246
    s_cbranch_vccnz L_lslow
    v_add_f32 v182, v182, v208
    v_add_f32 v183, v183, v209
    v_add_f32 v184, v184, v210
    v_add_f32 v185, v185, v211
    v_add_f32 v186, v186, v212
    v_add_f32 v187, v187, v213
    v_add_f32 v188, v188, v214
    v_add_f32 v189, v189, v215
    v_add_f32 v190, v190, v216
    v_add_f32 v191, v191, v217
    v_add_f32 v192, v192, v218
    v_add_f32 v166, v166, v182
    v_add_f32 v167, v167, v183
    v_add_f32 v168, v168, v184
    v_add_f32 v169, v169, v185
    v_add_f32 v170, v170, v186
    v_add_f32 v171, v171, v187
    v_add_f32 v172, v172, v188
    v_add_f32 v173, v173, v189
    v_add_f32 v174, v174, v190
    v_add_f32 v175, v175, v191
    v_add_f32 v176, v176, v192
L_l2:
    s_waitcnt lgkmcnt(0)
    v_cmp_ne_u32 vcc, 1, v247
    s_cbranch_vccnz L_l2w
    v_add_f32 v166, v166, v224
    v_add_f32 v167, v167, v225
    v_add_f32 v168, v168, v226
    v_add_f32 v169, v169, v227
    v_add_f32 v170, v170, v228
    v_add_f32 v171, v171, v229
    v_add_f32 v172, v172, v230
    v_add_f32 v173, v173, v231
    v_add_f32 v174, v174, v232
    v_add_f32 v175, v175, v233
    v_add_f32 v176, v176, v234
    v_subrev_u32 v182, 0x21800000, v176
    v_cmp_lt_u32 vcc, 0x3c000000, v182
    s_cbranch_vccnz L_fallback
    v_rcp_f32 v176, v176
    s_or_b32 s54, s72, s73
    v_mul_f32 v166, v166, v176
    v_mul_f32 v167, v167, v176
    v_mul_f32 v168, v168, v176
    v_mul_f32 v169, v169, v176
    v_mul_f32 v170, v170, v176
    v_mul_f32 v171, v171, v176
    v_mul_f32 v172, v172, v176
    v_mul_f32 v173, v173, v176
    v_mul_f32 v174, v174, v176
    v_mul_f32 v175, v175, v176
    v_cvt_pk_bf16_f32 v236, v166, v167
    v_cvt_pk_bf16_f32 v237, v168, v169
    v_cvt_pk_bf16_f32 v238, v170, v171
    v_cvt_pk_bf16_f32 v239, v172, v173
    v_cvt_pk_bf16_f32 v240, v174, v175
L_ostm:
    s_cbranch_scc1 L_oscm
    buffer_store_dwordx4 v[236:239], v2, s[40:43], s60 offen
    buffer_store_dword v240, v16, s[40:43], s61 offen
L_osdm:
    s_mov_b64 exec, 1
    ds_write_b8 v5, v13 offset:24
    s_mov_b64 exec, -1
    s_setprio 0
    s_branch L_work
L_lslow:
    s_add_u32 s64, s64, 1
    s_cmp_lt_u32 s64, 1000000
    s_cbranch_scc0 L_end
    ds_read_b32 v246, v7
    s_waitcnt lgkmcnt(0)
    v_cmp_ne_u32 vcc, 0x01010101, v246
    s_cbranch_vccnz L_lslow
    ds_read_b32 v246, v7
    ds_read_b128 v[182:185], v10 offset:0
    ds_read_b128 v[186:189], v10 offset:1024
    ds_read_b128 v[190:193], v10 offset:2048
    ds_read_b128 v[208:211], v10 offset:9216
    ds_read_b128 v[212:215], v10 offset:10240
    ds_read_b128 v[216:219], v10 offset:11264
    ds_read_u8 v247, v5 offset:46
    ds_read_b128 v[224:227], v255 offset:3072
    ds_read_b128 v[228:231], v255 offset:4096
    ds_read_b128 v[232:235], v255 offset:5120
    s_waitcnt lgkmcnt(0)
    s_branch L_lrd
L_l2w:
    s_add_u32 s64, s64, 1
    s_cmp_lt_u32 s64, 1000000
    s_cbranch_scc0 L_end
    ds_read_u8 v247, v5 offset:46
    ds_read_b128 v[224:227], v255 offset:3072
    ds_read_b128 v[228:231], v255 offset:4096
    ds_read_b128 v[232:235], v255 offset:5120
    s_waitcnt lgkmcnt(0)
    s_branch L_l2
L_t0:
    s_nop 5
    ds_write_b128 v255, v[166:169] offset:3072
    ds_write_b128 v255, v[170:173] offset:4096
    ds_write_b128 v255, v[174:177] offset:5120
    s_mov_b64 exec, 1
    ds_write_b8 v5, v13 offset:48
    s_mov_b64 exec, -1
    s_cmp_eq_u32 s85, 0
    s_cbranch_scc0 L_dfb
L_ws1:
    ds_read_b64 v[14:15], v6 offset:16
    ds_read_b64_tr_b16 v[38:39], v8 offset:0
    ds_read_b64_tr_b16 v[40:41], v8 offset:2560
    ds_read_b64_tr_b16 v[42:43], v8 offset:32
    ds_read_b64_tr_b16 v[44:45], v8 offset:2592
    ds_read_b64_tr_b16 v[46:47], v8 offset:64
    ds_read_b64_tr_b16 v[48:49], v8 offset:2624
    ds_read_b64_tr_b16 v[50:51], v8 offset:96
    ds_read_b64_tr_b16 v[52:53], v8 offset:2656
    s_waitcnt lgkmcnt(8)
    v_and_b32 v14, v14, v15
    v_cmp_ne_u32 vcc, 0x01010101, v14
    s_cbranch_vccnz L_wr1
    buffer_load_dwordx4 v[118:121], v2, s[40:43], s67 offen sc1
    buffer_load_dwordx4 v[122:125], v2, s[40:43], s67 offen offset:1024 sc1
    buffer_load_dwordx2 v[134:135], v16, s[40:43], s67 offen offset:2048 sc1
    buffer_load_dwordx4 v[126:129], v2, s[40:43], s68 offen sc1
    buffer_load_dwordx4 v[130:133], v2, s[40:43], s68 offen offset:1024 sc1
    buffer_load_dwordx2 v[136:137], v16, s[40:43], s68 offen offset:2048 sc1
    ds_read_b64_tr_b16 v[54:55], v8 offset:128
    ds_read_b64_tr_b16 v[56:57], v8 offset:2688
    ds_read_b64_tr_b16 v[58:59], v8 offset:5120
    ds_read_b64_tr_b16 v[60:61], v8 offset:7680
    ds_read_b64_tr_b16 v[62:63], v8 offset:5152
    ds_read_b64_tr_b16 v[64:65], v8 offset:7712
    ds_read_b64_tr_b16 v[66:67], v8 offset:5184
    ds_read_b64_tr_b16 v[68:69], v8 offset:7744
    ds_read_b64_tr_b16 v[70:71], v8 offset:5216
    ds_read_b64_tr_b16 v[72:73], v8 offset:7776
    ds_read_b64_tr_b16 v[74:75], v8 offset:5248
    ds_read_b64_tr_b16 v[76:77], v8 offset:7808
    ds_read_b64_tr_b16 v[78:79], v8 offset:10240
    ds_read_b64_tr_b16 v[80:81], v8 offset:12800
    ds_read_b64_tr_b16 v[82:83], v8 offset:10272
    ds_read_b64_tr_b16 v[84:85], v8 offset:12832
    ds_read_b64_tr_b16 v[86:87], v8 offset:10304
    ds_read_b64_tr_b16 v[88:89], v8 offset:12864
    ds_read_b64_tr_b16 v[90:91], v8 offset:10336
    ds_read_b64_tr_b16 v[92:93], v8 offset:12896
    ds_read_b64_tr_b16 v[94:95], v8 offset:10368
    ds_read_b64_tr_b16 v[96:97], v8 offset:12928
    ds_read_b64_tr_b16 v[98:99], v8 offset:15360
    ds_read_b64_tr_b16 v[100:101], v8 offset:17920
    ds_read_b64_tr_b16 v[102:103], v8 offset:15392
    ds_read_b64_tr_b16 v[104:105], v8 offset:17952
    ds_read_b64_tr_b16 v[106:107], v8 offset:15424
    ds_read_b64_tr_b16 v[108:109], v8 offset:17984
    ds_read_b64_tr_b16 v[110:111], v8 offset:15456
    ds_read_b64_tr_b16 v[112:113], v8 offset:18016
    ds_read_b64_tr_b16 v[114:115], v8 offset:15488
    ds_read_b64_tr_b16 v[116:117], v8 offset:18048
    ds_read_b64_tr_b16 v[138:139], v8 offset:20480
    ds_read_b64_tr_b16 v[140:141], v8 offset:23040
    ds_read_b64_tr_b16 v[142:143], v8 offset:20512
    ds_read_b64_tr_b16 v[144:145], v8 offset:23072
    ds_read_b64_tr_b16 v[146:147], v8 offset:20544
    ds_read_b64_tr_b16 v[148:149], v8 offset:23104
    ds_read_b64_tr_b16 v[150:151], v8 offset:20576
    ds_read_b64_tr_b16 v[152:153], v8 offset:23136
    ds_read_b64_tr_b16 v[154:155], v8 offset:20608
    ds_read_b64_tr_b16 v[156:157], v8 offset:23168
L_work:
    s_setprio 0
    s_waitcnt vmcnt(3)
    v_max_u32 v14, v134, v135
    v_max3_u32 v14, v14, v121, v125
    v_cmp_eq_u32 vcc, -1, v14
    s_cbranch_vccnz L_oslow00
L_ochk00:
    s_waitcnt lgkmcnt(15)
    v_mfma_f32_16x16x32_bf16 v[158:161], v[38:41], v[118:121], 0
    v_mfma_f32_16x16x32_bf16 v[162:165], v[42:45], v[118:121], 0
    v_mfma_f32_16x16x32_bf16 v[178:181], v[46:49], v[118:121], 0
    v_mfma_f32_16x16x32_bf16 v[202:205], v[50:53], v[118:121], 0
    ds_read_u16 v246, v6 offset:28
    v_mfma_f32_16x16x32_bf16 v[220:223], v[54:57], v[118:121], 0
    v_mfma_f32_16x16x32_bf16 v[158:161], v[58:61], v[122:125], v[158:161]
    v_mfma_f32_16x16x32_bf16 v[162:165], v[62:65], v[122:125], v[162:165]
    v_mfma_f32_16x16x32_bf16 v[178:181], v[66:69], v[122:125], v[178:181]
    s_waitcnt vmcnt(0)
    v_max_u32 v14, v136, v137
    v_mfma_f32_16x16x32_bf16 v[202:205], v[70:73], v[122:125], v[202:205]
    v_max3_u32 v14, v14, v129, v133
    s_waitcnt lgkmcnt(0)
L_fcp2:
    v_cmp_ne_u32 vcc, 0x0101, v246
    s_cbranch_vccnz L_fsp2
    v_mfma_f32_16x16x32_bf16 v[220:223], v[74:77], v[122:125], v[220:223]
    v_cmp_eq_u32 vcc, -1, v14
    s_cbranch_vccnz L_oslow01
L_ochk01:
    s_add_u32 s56, s67, 40960
    buffer_load_dwordx4 v[182:185], v2, s[40:43], s56 offen sc1
    v_mfma_f32_16x16x32_bf16 v[158:161], v[78:81], v[126:129], v[158:161]
    buffer_load_dwordx4 v[186:189], v2, s[40:43], s56 offen offset:1024 sc1
    v_mfma_f32_16x16x32_bf16 v[162:165], v[82:85], v[126:129], v[162:165]
    buffer_load_dwordx2 v[198:199], v16, s[40:43], s56 offen offset:2048 sc1
    v_mfma_f32_16x16x32_bf16 v[178:181], v[86:89], v[126:129], v[178:181]
    s_add_u32 s56, s68, 40960
    buffer_load_dwordx4 v[190:193], v2, s[40:43], s56 offen sc1
    v_mfma_f32_16x16x32_bf16 v[202:205], v[90:93], v[126:129], v[202:205]
    buffer_load_dwordx4 v[194:197], v2, s[40:43], s56 offen offset:1024 sc1
    v_mfma_f32_16x16x32_bf16 v[220:223], v[94:97], v[126:129], v[220:223]
    buffer_load_dwordx2 v[200:201], v16, s[40:43], s56 offen offset:2048 sc1
    v_mfma_f32_16x16x32_bf16 v[158:161], v[98:101], v[130:133], v[158:161]
    v_mfma_f32_16x16x32_bf16 v[162:165], v[102:105], v[130:133], v[162:165]
    v_mfma_f32_16x16x32_bf16 v[178:181], v[106:109], v[130:133], v[178:181]
    v_mfma_f32_16x16x32_bf16 v[202:205], v[110:113], v[130:133], v[202:205]
    v_mfma_f32_16x16x32_bf16 v[220:223], v[114:117], v[130:133], v[220:223]
    v_mfma_f32_16x16x32_bf16 v[158:161], v[138:141], v[134:137], v[158:161]
    v_mfma_f32_16x16x32_bf16 v[162:165], v[142:145], v[134:137], v[162:165]
    v_mfma_f32_16x16x32_bf16 v[178:181], v[146:149], v[134:137], v[178:181]
    v_mfma_f32_16x16x32_bf16 v[202:205], v[150:153], v[134:137], v[202:205]
    v_mfma_f32_16x16x32_bf16 v[220:223], v[154:157], v[134:137], v[220:223]
L_work2:
    ds_read_u16 v246, v6 offset:26
    s_waitcnt vmcnt(3)
    v_max_u32 v14, v198, v199
    v_max3_u32 v14, v14, v185, v189
    v_cmp_eq_u32 vcc, -1, v14
    s_cbranch_vccnz L_oslow20
L_ochk20:
    v_mfma_f32_16x16x32_bf16 v[18:21], v[38:41], v[182:185], 0
    v_mfma_f32_16x16x32_bf16 v[22:25], v[42:45], v[182:185], 0
    v_mfma_f32_16x16x32_bf16 v[26:29], v[46:49], v[182:185], 0
    s_waitcnt lgkmcnt(0)
L_fcp1:
    v_cmp_ne_u32 vcc, 0x0101, v246
    s_cbranch_vccnz L_fsp1
    v_mfma_f32_16x16x32_bf16 v[30:33], v[50:53], v[182:185], 0
    s_add_u32 s56, s67, 20480
    buffer_load_dwordx4 v[118:121], v2, s[40:43], s56 offen sc1
    v_mfma_f32_16x16x32_bf16 v[34:37], v[54:57], v[182:185], 0
    ds_write_b128 v254, v[158:161] offset:0
    buffer_load_dwordx4 v[122:125], v2, s[40:43], s56 offen offset:1024 sc1
    v_mfma_f32_16x16x32_bf16 v[18:21], v[58:61], v[186:189], v[18:21]
    buffer_load_dwordx2 v[134:135], v16, s[40:43], s56 offen offset:2048 sc1
    v_mfma_f32_16x16x32_bf16 v[22:25], v[62:65], v[186:189], v[22:25]
    ds_write_b128 v254, v[162:165] offset:32
    s_add_u32 s56, s68, 20480
    buffer_load_dwordx4 v[126:129], v2, s[40:43], s56 offen sc1
    v_mfma_f32_16x16x32_bf16 v[26:29], v[66:69], v[186:189], v[26:29]
    s_waitcnt vmcnt(4)
    v_max_u32 v14, v200, v201
    buffer_load_dwordx4 v[130:133], v2, s[40:43], s56 offen offset:1024 sc1
    v_mfma_f32_16x16x32_bf16 v[30:33], v[70:73], v[186:189], v[30:33]
    v_max3_u32 v14, v14, v193, v197
    buffer_load_dwordx2 v[136:137], v16, s[40:43], s56 offen offset:2048 sc1
    v_mfma_f32_16x16x32_bf16 v[34:37], v[74:77], v[186:189], v[34:37]
    v_cmp_eq_u32 vcc, -1, v14
    s_cbranch_vccnz L_oslow21
L_ochk21:
    v_mfma_f32_16x16x32_bf16 v[18:21], v[78:81], v[190:193], v[18:21]
    ds_write_b128 v254, v[178:181] offset:64
    v_mfma_f32_16x16x32_bf16 v[18:21], v[98:101], v[194:197], v[18:21]
    v_mfma_f32_16x16x32_bf16 v[22:25], v[82:85], v[190:193], v[22:25]
    v_mfma_f32_16x16x32_bf16 v[18:21], v[138:141], v[198:201], v[18:21]
    v_mfma_f32_16x16x32_bf16 v[22:25], v[102:105], v[194:197], v[22:25]
    ds_write_b128 v254, v[202:205] offset:96
    v_mfma_f32_16x16x32_bf16 v[26:29], v[86:89], v[190:193], v[26:29]
    v_mfma_f32_16x16x32_bf16 v[22:25], v[142:145], v[198:201], v[22:25]
    ds_write_b128 v254, v[18:21] offset:11264
    v_mfma_f32_16x16x32_bf16 v[26:29], v[106:109], v[194:197], v[26:29]
    v_mfma_f32_16x16x32_bf16 v[30:33], v[90:93], v[190:193], v[30:33]
    ds_write_b128 v254, v[220:223] offset:128
    s_mov_b64 exec, 1
    ds_write_b8 v5, v13 offset:32
    s_mov_b64 exec, -1
    v_mfma_f32_16x16x32_bf16 v[26:29], v[146:149], v[198:201], v[26:29]
    ds_write_b128 v254, v[22:25] offset:11296
    v_mfma_f32_16x16x32_bf16 v[30:33], v[110:113], v[194:197], v[30:33]
    v_mfma_f32_16x16x32_bf16 v[34:37], v[94:97], v[190:193], v[34:37]
    v_mfma_f32_16x16x32_bf16 v[30:33], v[150:153], v[198:201], v[30:33]
    ds_write_b128 v254, v[26:29] offset:11328
    s_waitcnt vmcnt(3)
    v_max_u32 v14, v134, v135
    v_mfma_f32_16x16x32_bf16 v[34:37], v[114:117], v[194:197], v[34:37]
    v_max3_u32 v14, v14, v121, v125
    v_mfma_f32_16x16x32_bf16 v[34:37], v[154:157], v[198:201], v[34:37]
    s_nop 3
    ds_write_b128 v254, v[30:33] offset:11360
    s_nop 2
    ds_write_b128 v254, v[34:37] offset:11392
    s_mov_b64 exec, 1
    ds_write_b8 v5, v13 offset:40
    s_mov_b64 exec, -1
    v_cmp_eq_u32 vcc, -1, v14
    s_cbranch_vccnz L_oslow10
L_ochk10:
    v_mfma_f32_16x16x32_bf16 v[222:225], v[38:41], v[118:121], 0
    v_mfma_f32_16x16x32_bf16 v[226:229], v[42:45], v[118:121], 0
    v_mfma_f32_16x16x32_bf16 v[230:233], v[46:49], v[118:121], 0
    v_mfma_f32_16x16x32_bf16 v[234:237], v[50:53], v[118:121], 0
    v_mfma_f32_16x16x32_bf16 v[238:241], v[54:57], v[118:121], 0
    ds_read_u16 v246, v6 offset:30
    v_mfma_f32_16x16x32_bf16 v[222:225], v[58:61], v[122:125], v[222:225]
    v_mfma_f32_16x16x32_bf16 v[226:229], v[62:65], v[122:125], v[226:229]
    v_mfma_f32_16x16x32_bf16 v[230:233], v[66:69], v[122:125], v[230:233]
    s_waitcnt vmcnt(0)
    v_max_u32 v14, v136, v137
    v_mfma_f32_16x16x32_bf16 v[234:237], v[70:73], v[122:125], v[234:237]
    v_max3_u32 v14, v14, v129, v133
    v_mfma_f32_16x16x32_bf16 v[238:241], v[74:77], v[122:125], v[238:241]
    v_cmp_eq_u32 vcc, -1, v14
    s_cbranch_vccnz L_oslow11
L_ochk11:
    s_waitcnt lgkmcnt(0)
L_fcp3:
    v_cmp_ne_u32 vcc, 0x0101, v246
    s_cbranch_vccnz L_fsp3
    v_mfma_f32_16x16x32_bf16 v[222:225], v[78:81], v[126:129], v[222:225]
    s_add_u32 s56, s67, 61440
    buffer_load_dwordx4 v[158:161], v2, s[40:43], s56 offen sc1
    v_mfma_f32_16x16x32_bf16 v[222:225], v[98:101], v[130:133], v[222:225]
    buffer_load_dwordx4 v[162:165], v2, s[40:43], s56 offen offset:1024 sc1
    v_mfma_f32_16x16x32_bf16 v[226:229], v[82:85], v[126:129], v[226:229]
    buffer_load_dwordx2 v[174:175], v16, s[40:43], s56 offen offset:2048 sc1
    v_mfma_f32_16x16x32_bf16 v[222:225], v[138:141], v[134:137], v[222:225]
    s_add_u32 s56, s68, 61440
    buffer_load_dwordx4 v[166:169], v2, s[40:43], s56 offen sc1
    v_mfma_f32_16x16x32_bf16 v[226:229], v[102:105], v[130:133], v[226:229]
    buffer_load_dwordx4 v[170:173], v2, s[40:43], s56 offen offset:1024 sc1
    v_mfma_f32_16x16x32_bf16 v[230:233], v[86:89], v[126:129], v[230:233]
    buffer_load_dwordx2 v[176:177], v16, s[40:43], s56 offen offset:2048 sc1
    v_mfma_f32_16x16x32_bf16 v[226:229], v[142:145], v[134:137], v[226:229]
    ds_write_b128 v254, v[222:225] offset:5632
    v_mfma_f32_16x16x32_bf16 v[230:233], v[106:109], v[130:133], v[230:233]
    v_mfma_f32_16x16x32_bf16 v[234:237], v[90:93], v[126:129], v[234:237]
    v_mfma_f32_16x16x32_bf16 v[230:233], v[146:149], v[134:137], v[230:233]
    ds_write_b128 v254, v[226:229] offset:5664
    v_mfma_f32_16x16x32_bf16 v[234:237], v[110:113], v[130:133], v[234:237]
    v_mfma_f32_16x16x32_bf16 v[238:241], v[94:97], v[126:129], v[238:241]
    v_mfma_f32_16x16x32_bf16 v[234:237], v[150:153], v[134:137], v[234:237]
    ds_write_b128 v254, v[230:233] offset:5696
    v_mfma_f32_16x16x32_bf16 v[238:241], v[114:117], v[130:133], v[238:241]
    v_mfma_f32_16x16x32_bf16 v[238:241], v[154:157], v[134:137], v[238:241]
    s_nop 3
    ds_write_b128 v254, v[234:237] offset:5728
    s_nop 2
    ds_write_b128 v254, v[238:241] offset:5760
    s_mov_b64 exec, 1
    ds_write_b8 v5, v13 offset:36
    s_mov_b64 exec, -1
    s_waitcnt vmcnt(3)
    v_max_u32 v14, v174, v175
    v_max3_u32 v14, v14, v161, v165
    v_cmp_eq_u32 vcc, -1, v14
    s_cbranch_vccnz L_oslow30
L_ochk30:
    v_mfma_f32_16x16x32_bf16 v[202:205], v[38:41], v[158:161], 0
    v_mfma_f32_16x16x32_bf16 v[206:209], v[42:45], v[158:161], 0
    v_mfma_f32_16x16x32_bf16 v[210:213], v[46:49], v[158:161], 0
    v_mfma_f32_16x16x32_bf16 v[214:217], v[50:53], v[158:161], 0
    v_mfma_f32_16x16x32_bf16 v[218:221], v[54:57], v[158:161], 0
    v_mfma_f32_16x16x32_bf16 v[202:205], v[58:61], v[162:165], v[202:205]
    v_mfma_f32_16x16x32_bf16 v[206:209], v[62:65], v[162:165], v[206:209]
    v_mfma_f32_16x16x32_bf16 v[210:213], v[66:69], v[162:165], v[210:213]
    s_waitcnt vmcnt(0)
    v_max_u32 v14, v176, v177
    v_mfma_f32_16x16x32_bf16 v[214:217], v[70:73], v[162:165], v[214:217]
    v_max3_u32 v14, v14, v169, v173
    v_mfma_f32_16x16x32_bf16 v[218:221], v[74:77], v[162:165], v[218:221]
    v_cmp_eq_u32 vcc, -1, v14
    s_cbranch_vccnz L_oslow31
L_ochk31:
    v_mfma_f32_16x16x32_bf16 v[202:205], v[78:81], v[166:169], v[202:205]
    v_mfma_f32_16x16x32_bf16 v[202:205], v[98:101], v[170:173], v[202:205]
    v_mfma_f32_16x16x32_bf16 v[206:209], v[82:85], v[166:169], v[206:209]
    v_mfma_f32_16x16x32_bf16 v[202:205], v[138:141], v[174:177], v[202:205]
    v_mfma_f32_16x16x32_bf16 v[206:209], v[102:105], v[170:173], v[206:209]
    v_mfma_f32_16x16x32_bf16 v[210:213], v[86:89], v[166:169], v[210:213]
    v_mfma_f32_16x16x32_bf16 v[206:209], v[142:145], v[174:177], v[206:209]
    ds_write_b128 v254, v[202:205] offset:16896
    v_mfma_f32_16x16x32_bf16 v[210:213], v[106:109], v[170:173], v[210:213]
    v_mfma_f32_16x16x32_bf16 v[214:217], v[90:93], v[166:169], v[214:217]
    v_mfma_f32_16x16x32_bf16 v[210:213], v[146:149], v[174:177], v[210:213]
    ds_write_b128 v254, v[206:209] offset:16928
    v_mfma_f32_16x16x32_bf16 v[214:217], v[110:113], v[170:173], v[214:217]
    v_mfma_f32_16x16x32_bf16 v[218:221], v[94:97], v[166:169], v[218:221]
    v_mfma_f32_16x16x32_bf16 v[214:217], v[150:153], v[174:177], v[214:217]
    ds_write_b128 v254, v[210:213] offset:16960
    v_mfma_f32_16x16x32_bf16 v[218:221], v[114:117], v[170:173], v[218:221]
    v_mfma_f32_16x16x32_bf16 v[218:221], v[154:157], v[174:177], v[218:221]
    s_nop 3
    ds_write_b128 v254, v[214:217] offset:16992
    s_nop 2
    ds_write_b128 v254, v[218:221] offset:17024
    s_mov_b64 exec, 1
    ds_write_b8 v5, v13 offset:44
    s_mov_b64 exec, -1
    s_waitcnt lgkmcnt(0)
    s_branch L_fin
L_oslow00:
    s_add_u32 s64, s64, 1
    s_cmp_lt_u32 s64, 1000000
    s_cbranch_scc0 L_end
    buffer_load_dwordx4 v[118:121], v2, s[40:43], s67 offen sc1
    buffer_load_dwordx4 v[122:125], v2, s[40:43], s67 offen offset:1024 sc1
    buffer_load_dwordx2 v[134:135], v16, s[40:43], s67 offen offset:2048 sc1
    s_waitcnt vmcnt(3)
    v_max_u32 v14, v136, v137
    v_max3_u32 v14, v14, v129, v133
    v_cmp_eq_u32 vcc, -1, v14
    s_cbranch_vccz L_ok0
    buffer_load_dwordx4 v[126:129], v2, s[40:43], s68 offen sc1
    buffer_load_dwordx4 v[130:133], v2, s[40:43], s68 offen offset:1024 sc1
    buffer_load_dwordx2 v[136:137], v16, s[40:43], s68 offen offset:2048 sc1
L_ok0:
    s_waitcnt vmcnt(0)
    v_max_u32 v14, v134, v135
    v_max3_u32 v14, v14, v121, v125
    v_cmp_eq_u32 vcc, -1, v14
    s_cbranch_vccnz L_oslow00
    s_branch L_ochk00
L_oslow01:
    s_add_u32 s64, s64, 1
    s_cmp_lt_u32 s64, 1000000
    s_cbranch_scc0 L_end
    buffer_load_dwordx4 v[126:129], v2, s[40:43], s68 offen sc1
    buffer_load_dwordx4 v[130:133], v2, s[40:43], s68 offen offset:1024 sc1
    buffer_load_dwordx2 v[136:137], v16, s[40:43], s68 offen offset:2048 sc1
    s_waitcnt vmcnt(0)
    v_max_u32 v14, v136, v137
    v_max3_u32 v14, v14, v129, v133
    v_cmp_eq_u32 vcc, -1, v14
    s_cbranch_vccnz L_oslow01
    s_branch L_ochk01
L_oslow20:
    s_add_u32 s64, s64, 1
    s_cmp_lt_u32 s64, 1000000
    s_cbranch_scc0 L_end
    s_add_u32 s55, s67, 40960
    buffer_load_dwordx4 v[182:185], v2, s[40:43], s55 offen sc1
    buffer_load_dwordx4 v[186:189], v2, s[40:43], s55 offen offset:1024 sc1
    buffer_load_dwordx2 v[198:199], v16, s[40:43], s55 offen offset:2048 sc1
    s_waitcnt vmcnt(3)
    v_max_u32 v14, v200, v201
    v_max3_u32 v14, v14, v193, v197
    v_cmp_eq_u32 vcc, -1, v14
    s_cbranch_vccz L_ok2
    s_add_u32 s55, s68, 40960
    buffer_load_dwordx4 v[190:193], v2, s[40:43], s55 offen sc1
    buffer_load_dwordx4 v[194:197], v2, s[40:43], s55 offen offset:1024 sc1
    buffer_load_dwordx2 v[200:201], v16, s[40:43], s55 offen offset:2048 sc1
L_ok2:
    s_waitcnt vmcnt(0)
    v_max_u32 v14, v198, v199
    v_max3_u32 v14, v14, v185, v189
    v_cmp_eq_u32 vcc, -1, v14
    s_cbranch_vccnz L_oslow20
    s_branch L_ochk20
L_oslow21:
    s_add_u32 s64, s64, 1
    s_cmp_lt_u32 s64, 1000000
    s_cbranch_scc0 L_end
    s_add_u32 s55, s68, 40960
    buffer_load_dwordx4 v[190:193], v2, s[40:43], s55 offen sc1
    buffer_load_dwordx4 v[194:197], v2, s[40:43], s55 offen offset:1024 sc1
    buffer_load_dwordx2 v[200:201], v16, s[40:43], s55 offen offset:2048 sc1
    s_waitcnt vmcnt(0)
    v_max_u32 v14, v200, v201
    v_max3_u32 v14, v14, v193, v197
    v_cmp_eq_u32 vcc, -1, v14
    s_cbranch_vccnz L_oslow21
    s_branch L_ochk21
L_oslow10:
    s_add_u32 s64, s64, 1
    s_cmp_lt_u32 s64, 1000000
    s_cbranch_scc0 L_end
    s_add_u32 s55, s67, 20480
    buffer_load_dwordx4 v[118:121], v2, s[40:43], s55 offen sc1
    buffer_load_dwordx4 v[122:125], v2, s[40:43], s55 offen offset:1024 sc1
    buffer_load_dwordx2 v[134:135], v16, s[40:43], s55 offen offset:2048 sc1
    s_waitcnt vmcnt(3)
    v_max_u32 v14, v136, v137
    v_max3_u32 v14, v14, v129, v133
    v_cmp_eq_u32 vcc, -1, v14
    s_cbranch_vccz L_ok1
    s_add_u32 s55, s68, 20480
    buffer_load_dwordx4 v[126:129], v2, s[40:43], s55 offen sc1
    buffer_load_dwordx4 v[130:133], v2, s[40:43], s55 offen offset:1024 sc1
    buffer_load_dwordx2 v[136:137], v16, s[40:43], s55 offen offset:2048 sc1
L_ok1:
    s_waitcnt vmcnt(0)
    v_max_u32 v14, v134, v135
    v_max3_u32 v14, v14, v121, v125
    v_cmp_eq_u32 vcc, -1, v14
    s_cbranch_vccnz L_oslow10
    s_branch L_ochk10
L_oslow11:
    s_add_u32 s64, s64, 1
    s_cmp_lt_u32 s64, 1000000
    s_cbranch_scc0 L_end
    s_add_u32 s55, s68, 20480
    buffer_load_dwordx4 v[126:129], v2, s[40:43], s55 offen sc1
    buffer_load_dwordx4 v[130:133], v2, s[40:43], s55 offen offset:1024 sc1
    buffer_load_dwordx2 v[136:137], v16, s[40:43], s55 offen offset:2048 sc1
    s_waitcnt vmcnt(0)
    v_max_u32 v14, v136, v137
    v_max3_u32 v14, v14, v129, v133
    v_cmp_eq_u32 vcc, -1, v14
    s_cbranch_vccnz L_oslow11
    s_branch L_ochk11
L_oslow30:
    s_add_u32 s64, s64, 1
    s_cmp_lt_u32 s64, 1000000
    s_cbranch_scc0 L_end
    s_add_u32 s55, s67, 61440
    buffer_load_dwordx4 v[158:161], v2, s[40:43], s55 offen sc1
    buffer_load_dwordx4 v[162:165], v2, s[40:43], s55 offen offset:1024 sc1
    buffer_load_dwordx2 v[174:175], v16, s[40:43], s55 offen offset:2048 sc1
    s_waitcnt vmcnt(3)
    v_max_u32 v14, v176, v177
    v_max3_u32 v14, v14, v169, v173
    v_cmp_eq_u32 vcc, -1, v14
    s_cbranch_vccz L_ok3
    s_add_u32 s55, s68, 61440
    buffer_load_dwordx4 v[166:169], v2, s[40:43], s55 offen sc1
    buffer_load_dwordx4 v[170:173], v2, s[40:43], s55 offen offset:1024 sc1
    buffer_load_dwordx2 v[176:177], v16, s[40:43], s55 offen offset:2048 sc1
L_ok3:
    s_waitcnt vmcnt(0)
    v_max_u32 v14, v174, v175
    v_max3_u32 v14, v14, v161, v165
    v_cmp_eq_u32 vcc, -1, v14
    s_cbranch_vccnz L_oslow30
    s_branch L_ochk30
L_oslow31:
    s_add_u32 s64, s64, 1
    s_cmp_lt_u32 s64, 1000000
    s_cbranch_scc0 L_end
    s_add_u32 s55, s68, 61440
    buffer_load_dwordx4 v[166:169], v2, s[40:43], s55 offen sc1
    buffer_load_dwordx4 v[170:173], v2, s[40:43], s55 offen offset:1024 sc1
    buffer_load_dwordx2 v[176:177], v16, s[40:43], s55 offen offset:2048 sc1
    s_waitcnt vmcnt(0)
    v_max_u32 v14, v176, v177
    v_max3_u32 v14, v14, v169, v173
    v_cmp_eq_u32 vcc, -1, v14
    s_cbranch_vccnz L_oslow31
    s_branch L_ochk31
L_fsp3:
    ds_read_u16 v246, v6 offset:30
    s_add_u32 s64, s64, 1
    s_cmp_lt_u32 s64, 1000000
    s_cbranch_scc0 L_end
    s_waitcnt lgkmcnt(0)
    s_branch L_fcp3
L_fsp1:
    ds_read_u16 v246, v6 offset:26
    s_add_u32 s64, s64, 1
    s_cmp_lt_u32 s64, 1000000
    s_cbranch_scc0 L_end
    s_waitcnt lgkmcnt(0)
    s_branch L_fcp1
L_fsp2:
    ds_read_u16 v246, v6 offset:28
    s_add_u32 s64, s64, 1
    s_cmp_lt_u32 s64, 1000000
    s_cbranch_scc0 L_end
    s_waitcnt lgkmcnt(0)
    s_branch L_fcp2
L_dfb:
    s_mov_b32 s85, 0
    s_mov_b32 s60, s70
    s_mov_b32 s61, s71
    v_mov_b32 v5, v248
    v_mov_b32 v30, v22
    v_mov_b32 v31, v23
    v_mov_b32 v32, v24
    v_mov_b32 v33, v25
    v_mov_b32 v36, v34
    v_mov_b32 v37, v35
    s_branch L_fallback
L_wr0:
    s_add_u32 s64, s64, 1
    s_cmp_lt_u32 s64, 1000000
    s_cbranch_scc0 L_end
    s_waitcnt lgkmcnt(0)
    s_branch L_ws0
L_wr1:
    s_add_u32 s64, s64, 1
    s_cmp_lt_u32 s64, 1000000
    s_cbranch_scc0 L_end
    s_waitcnt lgkmcnt(0)
    s_branch L_ws1
L_wr2:
    s_add_u32 s64, s64, 1
    s_cmp_lt_u32 s64, 1000000
    s_cbranch_scc0 L_end
    s_waitcnt lgkmcnt(0)
    s_branch L_ws2
L_slow1:
    s_add_u32 s64, s64, 1
    s_cmp_lt_u32 s64, 1000000
    s_cbranch_scc0 L_end
    s_mov_b64 exec, s[72:73]
    buffer_load_dword v13, v5, s[40:43], 0 offen sc1
    s_mov_b64 exec, -1
    s_waitcnt vmcnt(0)
    v_cmp_ne_u32 s[72:73], s51, v13
    s_nop 0
    s_and_b32 s54, s72, 0xff00
    s_cbranch_scc1 L_slow1
    s_branch L_back1
L_slow2:
    s_add_u32 s64, s64, 1
    s_cmp_lt_u32 s64, 1000000
    s_cbranch_scc0 L_end
    s_mov_b64 exec, s[72:73]
    buffer_load_dword v13, v5, s[40:43], 0 offen sc1
    s_mov_b64 exec, -1
    s_waitcnt vmcnt(0)
    v_cmp_ne_u32 s[72:73], s51, v13
    s_nop 0
    s_and_b32 s54, s72, 0xff0000
    s_cbranch_scc1 L_slow2
    s_branch L_back2
L_slow3:
    s_add_u32 s64, s64, 1
    s_cmp_lt_u32 s64, 1000000
    s_cbranch_scc0 L_end
    s_mov_b64 exec, s[72:73]
    buffer_load_dword v13, v5, s[40:43], 0 offen sc1
    s_mov_b64 exec, -1
    s_waitcnt vmcnt(0)
    v_cmp_ne_u32 s[72:73], s51, v13
    s_nop 0
    s_and_b32 s54, s72, 0xff000000
    s_cbranch_scc1 L_slow3
    s_branch L_back3
L_slow4:
    s_add_u32 s64, s64, 1
    s_cmp_lt_u32 s64, 1000000
    s_cbranch_scc0 L_end
    s_mov_b64 exec, s[72:73]
    buffer_load_dword v13, v5, s[40:43], 0 offen sc1
    s_mov_b64 exec, -1
    s_waitcnt vmcnt(0)
    v_cmp_ne_u32 s[72:73], s51, v13
    s_nop 0
    s_and_b32 s54, s73, 0xff
    s_cbranch_scc1 L_slow4
    s_branch L_back4
L_slow5:
    s_add_u32 s64, s64, 1
    s_cmp_lt_u32 s64, 1000000
    s_cbranch_scc0 L_end
    s_mov_b64 exec, s[72:73]
    buffer_load_dword v13, v5, s[40:43], 0 offen sc1
    s_mov_b64 exec, -1
    s_waitcnt vmcnt(0)
    v_cmp_ne_u32 s[72:73], s51, v13
    s_nop 0
    s_and_b32 s54, s73, 0xff00
    s_cbranch_scc1 L_slow5
    s_branch L_back5
L_slow6:
    s_add_u32 s64, s64, 1
    s_cmp_lt_u32 s64, 1000000
    s_cbranch_scc0 L_end
    s_mov_b64 exec, s[72:73]
    buffer_load_dword v13, v5, s[40:43], 0 offen sc1
    s_mov_b64 exec, -1
    s_waitcnt vmcnt(0)
    v_cmp_ne_u32 s[72:73], s51, v13
    s_nop 0
    s_and_b32 s54, s73, 0xff0000
    s_cbranch_scc1 L_slow6
    s_branch L_back6
L_slow7:
    s_add_u32 s64, s64, 1
    s_cmp_lt_u32 s64, 1000000
    s_cbranch_scc0 L_end
    s_mov_b64 exec, s[72:73]
    buffer_load_dword v13, v5, s[40:43], 0 offen sc1
    s_mov_b64 exec, -1
    s_waitcnt vmcnt(0)
    v_cmp_ne_u32 s[72:73], s51, v13
    s_nop 0
    s_and_b32 s54, s73, 0xff000000
    s_cbranch_scc1 L_slow7
    s_branch L_back7
L_osce:
    buffer_store_dwordx4 v[236:239], v2, s[40:43], s70 offen sc1
    buffer_store_dword v240, v16, s[40:43], s71 offen sc1
    s_branch L_osde
L_oscl:
    buffer_store_dwordx4 v[236:239], v2, s[40:43], s60 offen sc1
    buffer_store_dword v240, v16, s[40:43], s61 offen sc1
    s_branch L_osdl
L_oscm:
    buffer_store_dwordx4 v[236:239], v2, s[40:43], s60 offen sc1
    buffer_store_dword v240, v16, s[40:43], s61 offen sc1
    s_branch L_osdm
L_defer:
    s_mov_b32 s85, 1
    s_branch L_deferred
L_slowf0:
    s_add_u32 s64, s64, 1
    s_cmp_lt_u32 s64, 1000000
    s_cbranch_scc0 L_end
    s_mov_b64 exec, 0xffff
    buffer_load_dword v15, v240, s[40:43], 0 offen sc1
    s_mov_b64 exec, -1
    s_waitcnt vmcnt(0)
    s_branch L_f0
L_slowf2:
    s_add_u32 s64, s64, 1
    s_cmp_lt_u32 s64, 1000000
    s_cbranch_scc0 L_end
    buffer_load_dword v15, v14, s[40:43], s76 offen sc1
    s_waitcnt vmcnt(0)
    s_branch L_f2
L_fallback:
    s_waitcnt lgkmcnt(0)
    v_mov_b32 v244, 0xff800000
    s_mov_b32 s54, 0
L_fb1:
    buffer_load_dwordx4 v[182:185], v2, s[40:43], s54 offen sc1
    buffer_load_dwordx2 v[186:187], v3, s[40:43], s54 offen offset:1024 sc1
    buffer_load_dwordx4 v[200:203], v4, s[40:43], s54 offen offset:1536 sc1
    buffer_load_dwordx4 v[204:207], v4, s[40:43], s54 offen offset:2304 sc1
    s_waitcnt vmcnt(0)
    s_mov_b32 exec_lo, 0x00440000
    s_mov_b32 exec_hi, 0x00440000
    v_mov_b32 v200, 0x3f803f80
    v_mov_b32 v201, 0x3f803f80
    v_mov_b32 v202, 0x3f803f80
    v_mov_b32 v203, 0x3f803f80
    v_mov_b32 v204, 0x3f803f80
    v_mov_b32 v205, 0x3f803f80
    v_mov_b32 v206, 0x3f803f80
    v_mov_b32 v207, 0x3f803f80
    s_mov_b64 exec, -1
    v_mfma_f32_32x32x4_2b_bf16 v[70:101], v[186:187], v[36:37], 0 cbsz:1
    s_nop 15
    s_nop 1
    v_mfma_f32_32x32x16_bf16 v[86:101], v[182:185], v[30:33], v[86:101]
    s_nop 11
    v_max3_f32 v244, v244, v86, v87
    v_max3_f32 v244, v244, v88, v89
    v_max3_f32 v244, v244, v90, v91
    v_max3_f32 v244, v244, v92, v93
    v_max3_f32 v244, v244, v94, v95
    v_max3_f32 v244, v244, v96, v97
    v_max3_f32 v244, v244, v98, v99
    v_max3_f32 v244, v244, v100, v101
    s_add_u32 s54, s54, 4096
    s_cmp_lt_u32 s54, 262144
    s_cbranch_scc1 L_fb1
    v_mov_b32 v245, v244
    s_nop 1
    v_permlane32_swap_b32 v244, v245
    s_nop 1
    v_max_f32 v244, v244, v245
    v_mov_b32 v166, 0
    v_mov_b32 v167, 0
    v_mov_b32 v168, 0
    v_mov_b32 v169, 0
    v_mov_b32 v170, 0
    v_mov_b32 v171, 0
    v_mov_b32 v172, 0
    v_mov_b32 v173, 0
    v_mov_b32 v174, 0
    v_mov_b32 v175, 0
    v_mov_b32 v176, 0
    v_mov_b32 v177, 0
    v_mov_b32 v178, 0
    v_mov_b32 v179, 0
    v_mov_b32 v180, 0
    v_mov_b32 v181, 0
    v_mov_b32 v104, 0xdddddddd
    s_mov_b32 s54, 0
L_fb2:
    buffer_load_dwordx4 v[182:185], v2, s[40:43], s54 offen sc1
    buffer_load_dwordx2 v[186:187], v3, s[40:43], s54 offen offset:1024 sc1
    buffer_load_dwordx4 v[200:203], v4, s[40:43], s54 offen offset:1536 sc1
    buffer_load_dwordx4 v[204:207], v4, s[40:43], s54 offen offset:2304 sc1
    s_waitcnt vmcnt(0)
    s_mov_b32 exec_lo, 0x00440000
    s_mov_b32 exec_hi, 0x00440000
    v_mov_b32 v200, 0x3f803f80
    v_mov_b32 v201, 0x3f803f80
    v_mov_b32 v202, 0x3f803f80
    v_mov_b32 v203, 0x3f803f80
    v_mov_b32 v204, 0x3f803f80
    v_mov_b32 v205, 0x3f803f80
    v_mov_b32 v206, 0x3f803f80
    v_mov_b32 v207, 0x3f803f80
    s_mov_b64 exec, -1
    v_mfma_f32_32x32x4_2b_bf16 v[70:101], v[186:187], v[36:37], 0 cbsz:1
    s_nop 15
    s_nop 1
    v_mfma_f32_32x32x16_bf16 v[86:101], v[182:185], v[30:33], v[86:101]
    s_nop 11
    v_sub_f32 v86, v86, v244
    v_sub_f32 v87, v87, v244
    v_sub_f32 v88, v88, v244
    v_sub_f32 v89, v89, v244
    v_sub_f32 v90, v90, v244
    v_sub_f32 v91, v91, v244
    v_sub_f32 v92, v92, v244
    v_sub_f32 v93, v93, v244
    v_sub_f32 v94, v94, v244
    v_sub_f32 v95, v95, v244
    v_sub_f32 v96, v96, v244
    v_sub_f32 v97, v97, v244
    v_sub_f32 v98, v98, v244
    v_sub_f32 v99, v99, v244
    v_sub_f32 v100, v100, v244
    v_sub_f32 v101, v101, v244
    v_exp_f32 v86, v86
    v_exp_f32 v87, v87
    v_exp_f32 v88, v88
    v_exp_f32 v89, v89
    v_exp_f32 v90, v90
    v_exp_f32 v91, v91
    v_exp_f32 v92, v92
    v_exp_f32 v93, v93
    v_exp_f32 v94, v94
    v_exp_f32 v95, v95
    v_exp_f32 v96, v96
    v_exp_f32 v97, v97
    v_exp_f32 v98, v98
    v_exp_f32 v99, v99
    v_exp_f32 v100, v100
    v_exp_f32 v101, v101
    s_nop 1
    v_smfmac_f32_32x32x32_bf16 v[166:181], v[200:203], v[86:93], v104
    v_smfmac_f32_32x32x32_bf16 v[166:181], v[204:207], v[94:101], v104
    s_add_u32 s54, s54, 4096
    s_cmp_lt_u32 s54, 262144
    s_cbranch_scc1 L_fb2
    s_nop 15
    s_cmp_eq_u32 s82, 0
    s_cbranch_scc0 L_blk12
L_ws2:
    ds_read_b64 v[14:15], v6 offset:16
    ds_read_b64_tr_b16 v[38:39], v8 offset:0
    ds_read_b64_tr_b16 v[40:41], v8 offset:2560
    ds_read_b64_tr_b16 v[42:43], v8 offset:32
    ds_read_b64_tr_b16 v[44:45], v8 offset:2592
    ds_read_b64_tr_b16 v[46:47], v8 offset:64
    ds_read_b64_tr_b16 v[48:49], v8 offset:2624
    ds_read_b64_tr_b16 v[50:51], v8 offset:96
    ds_read_b64_tr_b16 v[52:53], v8 offset:2656
    s_waitcnt lgkmcnt(8)
    v_and_b32 v14, v14, v15
    v_cmp_ne_u32 vcc, 0x01010101, v14
    s_cbranch_vccnz L_wr2
    buffer_load_dwordx4 v[118:121], v2, s[40:43], s67 offen sc1
    buffer_load_dwordx4 v[122:125], v2, s[40:43], s67 offen offset:1024 sc1
    buffer_load_dwordx2 v[134:135], v16, s[40:43], s67 offen offset:2048 sc1
    buffer_load_dwordx4 v[126:129], v2, s[40:43], s68 offen sc1
    buffer_load_dwordx4 v[130:133], v2, s[40:43], s68 offen offset:1024 sc1
    buffer_load_dwordx2 v[136:137], v16, s[40:43], s68 offen offset:2048 sc1
    ds_read_b64_tr_b16 v[54:55], v8 offset:128
    ds_read_b64_tr_b16 v[56:57], v8 offset:2688
    ds_read_b64_tr_b16 v[58:59], v8 offset:5120
    ds_read_b64_tr_b16 v[60:61], v8 offset:7680
    ds_read_b64_tr_b16 v[62:63], v8 offset:5152
    ds_read_b64_tr_b16 v[64:65], v8 offset:7712
    ds_read_b64_tr_b16 v[66:67], v8 offset:5184
    ds_read_b64_tr_b16 v[68:69], v8 offset:7744
    ds_read_b64_tr_b16 v[70:71], v8 offset:5216
    ds_read_b64_tr_b16 v[72:73], v8 offset:7776
    ds_read_b64_tr_b16 v[74:75], v8 offset:5248
    ds_read_b64_tr_b16 v[76:77], v8 offset:7808
    ds_read_b64_tr_b16 v[78:79], v8 offset:10240
    ds_read_b64_tr_b16 v[80:81], v8 offset:12800
    ds_read_b64_tr_b16 v[82:83], v8 offset:10272
    ds_read_b64_tr_b16 v[84:85], v8 offset:12832
    ds_read_b64_tr_b16 v[86:87], v8 offset:10304
    ds_read_b64_tr_b16 v[88:89], v8 offset:12864
    ds_read_b64_tr_b16 v[90:91], v8 offset:10336
    ds_read_b64_tr_b16 v[92:93], v8 offset:12896
    ds_read_b64_tr_b16 v[94:95], v8 offset:10368
    ds_read_b64_tr_b16 v[96:97], v8 offset:12928
    ds_read_b64_tr_b16 v[98:99], v8 offset:15360
    ds_read_b64_tr_b16 v[100:101], v8 offset:17920
    ds_read_b64_tr_b16 v[102:103], v8 offset:15392
    ds_read_b64_tr_b16 v[104:105], v8 offset:17952
    ds_read_b64_tr_b16 v[106:107], v8 offset:15424
    ds_read_b64_tr_b16 v[108:109], v8 offset:17984
    ds_read_b64_tr_b16 v[110:111], v8 offset:15456
    ds_read_b64_tr_b16 v[112:113], v8 offset:18016
    ds_read_b64_tr_b16 v[114:115], v8 offset:15488
    ds_read_b64_tr_b16 v[116:117], v8 offset:18048
    ds_read_b64_tr_b16 v[138:139], v8 offset:20480
    ds_read_b64_tr_b16 v[140:141], v8 offset:23040
    ds_read_b64_tr_b16 v[142:143], v8 offset:20512
    ds_read_b64_tr_b16 v[144:145], v8 offset:23072
    ds_read_b64_tr_b16 v[146:147], v8 offset:20544
    ds_read_b64_tr_b16 v[148:149], v8 offset:23104
    ds_read_b64_tr_b16 v[150:151], v8 offset:20576
    ds_read_b64_tr_b16 v[152:153], v8 offset:23136
    ds_read_b64_tr_b16 v[154:155], v8 offset:20608
    ds_read_b64_tr_b16 v[156:157], v8 offset:23168
    s_waitcnt lgkmcnt(0)
L_blk12:
    v_rcp_f32 v176, v176
    s_or_b32 s54, s72, s73
    v_mul_f32 v166, v166, v176
    v_mul_f32 v167, v167, v176
    v_mul_f32 v168, v168, v176
    v_mul_f32 v169, v169, v176
    v_mul_f32 v170, v170, v176
    v_mul_f32 v171, v171, v176
    v_mul_f32 v172, v172, v176
    v_mul_f32 v173, v173, v176
    v_mul_f32 v174, v174, v176
    v_mul_f32 v175, v175, v176
    v_cvt_pk_bf16_f32 v236, v166, v167
    v_cvt_pk_bf16_f32 v237, v168, v169
    v_cvt_pk_bf16_f32 v238, v170, v171
    v_cvt_pk_bf16_f32 v239, v172, v173
    v_cvt_pk_bf16_f32 v240, v174, v175
    v_min_u32 v236, -2, v236
    v_min_u32 v237, -2, v237
    v_min_u32 v238, -2, v238
    v_min_u32 v239, -2, v239
    v_min_u32 v240, -2, v240
L_last:
    s_branch L_ostl
.section .rodata,"a"
.p2align 6
.amdhsa_kernel standalone__grouped_kv_mqa__prompt_kernel
  .amdhsa_next_free_vgpr 256
  .amdhsa_next_free_sgpr 102
  .amdhsa_accum_offset 256
  .amdhsa_group_segment_fixed_size 0
  .amdhsa_kernarg_size 64
  .amdhsa_user_sgpr_count 2
  .amdhsa_user_sgpr_kernarg_segment_ptr 1
  .amdhsa_system_sgpr_workgroup_id_x 1
.end_amdhsa_kernel
```
